```python
import torch

def _softmax(x, axis=-1):
    return torch.softmax(x, dim=axis)
def _gelu(x):
    return torch.nn.functional.gelu(x, approximate="tanh")
def _silu(x):
    return torch.nn.functional.silu(x)
def _sigmoid(x):
    return torch.sigmoid(x)
def _layernorm(x, axis=-1, eps=1e-5):
    m = x.mean(dim=axis, keepdim=True)
    v = x.var(dim=axis, keepdim=True, unbiased=False)
    return (x - m) / torch.sqrt(v + eps)
def _scatter_add(tgt, idx, src, axis=0):
    return tgt.clone().index_add_(axis, idx, src)
def _segment_sum(src, seg, n):
    out = torch.zeros((n,) + src.shape[1:], dtype=src.dtype)
    return out.index_add_(0, seg, src)
def _pad(x, pw):
    flat = tuple(v for pair in reversed(pw) for v in pair)
    return torch.nn.functional.pad(x, flat)

kernel_name = 'interleave_layers__sliding_block_cached__sliding_block_cached__decode'

def setup_inputs():

    _w = (lambda a: (lambda t: t.to(torch.bfloat16) if t.is_floating_point() else t)(torch.as_tensor(a)))
    def _A_setup():
        B, Sq, D = 1, 1, 1024
        Hq, Hkv, Sk, Dh = 32, 4, 65536, 128
        assert Hq % Hkv == 0, (Hq, Hkv)
        return {
            "x": _w((lambda *s: torch.randn(*s, dtype=torch.bfloat16) * 0.05)(B, Sq, D)),
            "k_cache": _w((lambda *s: torch.randn(*s, dtype=torch.bfloat16) * 0.8)(B, Hkv, Sk, Dh)),
            "v_cache": _w((lambda *s: torch.randn(*s, dtype=torch.bfloat16) * 3.2)(B, Hkv, Sk, Dh)),
            "wq": _w((lambda *s: torch.randn(*s, dtype=torch.bfloat16) * 0.8)(D, Hq * Dh) * (D ** -0.5)),
            "wo": _w((lambda *s: torch.randn(*s, dtype=torch.bfloat16) * 3.2)(Hq * Dh, D) * ((Hq * Dh) ** -0.5)),
        }
    _A_in = _A_setup()

    def _B_setup():
        B, Sq, D = 1, 1, 1024
        Hq, Hkv, Sk, Dh = 32, 4, 65536, 128
        assert Hq % Hkv == 0, (Hq, Hkv)
        return {
            "x": _w((lambda *s: torch.randn(*s, dtype=torch.bfloat16) * 0.05)(B, Sq, D)),
            "k_cache": _w((lambda *s: torch.randn(*s, dtype=torch.bfloat16) * 1.6)(B, Hkv, Sk, Dh)),
            "v_cache": _w((lambda *s: torch.randn(*s, dtype=torch.bfloat16) * 1.6)(B, Hkv, Sk, Dh)),
            "wq": _w((lambda *s: torch.randn(*s, dtype=torch.bfloat16) * 1.6)(D, Hq * Dh) * (D ** -0.5)),
            "wo": _w((lambda *s: torch.randn(*s, dtype=torch.bfloat16) * 1.6)(Hq * Dh, D) * ((Hq * Dh) ** -0.5)),
        }
    _B_in = _B_setup()

    return {
        "A_x": _A_in["x"],
        "A_k_cache": _A_in["k_cache"],
        "A_v_cache": _A_in["v_cache"],
        "A_wq": _A_in["wq"],
        "A_wo": _A_in["wo"],
        "B_x": _B_in["x"],
        "B_k_cache": _B_in["k_cache"],
        "B_v_cache": _B_in["v_cache"],
        "B_wq": _B_in["wq"],
        "B_wo": _B_in["wo"],
    }

def reference(A_x, A_k_cache, A_v_cache, A_wq, A_wo, B_x, B_k_cache, B_v_cache, B_wq, B_wo):
    def _A_ref(x, k_cache, v_cache, wq, wo):
        B, Sq, D = x.shape
        Hq, Dh = 32, 128
        Hkv, Sk = k_cache.shape[1], k_cache.shape[2]
        W = min(4096, max(256, Sk // 4))
        rep = Hq // Hkv
        q = (lambda x, *d: x.permute(*d))((x @ wq).reshape(B, Sq, Hq, Dh), 0, 2, 1, 3)
        k = (lambda x, n, axis: torch.repeat_interleave(x, n, dim=axis))(k_cache[:, :, Sk - W:, :], rep, axis=1)
        v = (lambda x, n, axis: torch.repeat_interleave(x, n, dim=axis))(v_cache[:, :, Sk - W:, :], rep, axis=1)
        scores = torch.einsum("bhqd,bhkd->bhqk", q, k) * (Dh ** -0.5)
        p = _softmax(scores, axis=-1)
        o = torch.einsum("bhqk,bhkd->bhqd", p, v)
        return (lambda x, *d: x.permute(*d))(o, 0, 2, 1, 3).reshape(B, Sq, Hq * Dh) @ wo

    def _B_ref(x, k_cache, v_cache, wq, wo):
        B, Sq, D = x.shape
        Hq, Dh = 32, 128
        Hkv, Sk = k_cache.shape[1], k_cache.shape[2]
        W = min(4096, max(256, Sk // 4))
        rep = Hq // Hkv
        q = (lambda x, *d: x.permute(*d))((x @ wq).reshape(B, Sq, Hq, Dh), 0, 2, 1, 3)
        k = (lambda x, n, axis: torch.repeat_interleave(x, n, dim=axis))(k_cache[:, :, Sk - W:, :], rep, axis=1)
        v = (lambda x, n, axis: torch.repeat_interleave(x, n, dim=axis))(v_cache[:, :, Sk - W:, :], rep, axis=1)
        scores = torch.einsum("bhqd,bhkd->bhqk", q, k) * (Dh ** -0.5)
        p = _softmax(scores, axis=-1)
        o = torch.einsum("bhqk,bhkd->bhqd", p, v)
        return (lambda x, *d: x.permute(*d))(o, 0, 2, 1, 3).reshape(B, Sq, Hq * Dh) @ wo

    x = A_x
    x = x + _A_ref(_layernorm(x, axis=-1), A_k_cache, A_v_cache, A_wq, A_wo)
    x = x + _B_ref(_layernorm(x, axis=-1), B_k_cache, B_v_cache, B_wq, B_wo)
    x = x + _A_ref(_layernorm(x, axis=-1), A_k_cache, A_v_cache, A_wq, A_wo)
    x = x + _B_ref(_layernorm(x, axis=-1), B_k_cache, B_v_cache, B_wq, B_wo)
    return x
```

```asm
; @launch grid=(256,1,1) block=(512,1,1) lds=139264
.amdgcn_target "amdgcn-amd-amdhsa--gfx950"
.text
.globl interleave_layers__sliding_block_cached__sliding_block_cached__decode_kernel
.p2align 8
.type interleave_layers__sliding_block_cached__sliding_block_cached__decode_kernel,@function
interleave_layers__sliding_block_cached__sliding_block_cached__decode_kernel:
    s_cmp_ge_u32 s2, 256
    s_cbranch_scc1 EXIT
    s_bfe_u32 s35, s2, 0x10002
    s_mul_i32 s58, s35, 40
    s_add_u32 s58, s58, 8
    s_load_dwordx8 s[84:91], s[0:1], s58
    s_load_dwordx2 s[92:93], s[0:1], 96
    s_load_dwordx2 s[8:9], s[0:1], 0
    s_load_dwordx2 s[12:13], s[0:1], 80
    v_lshrrev_b32 v1, 6, v0
    v_and_b32 v63, 63, v0
    v_readfirstlane_b32 s3, v1
    v_mov_b32 v19, 0
    v_lshlrev_b32 v20, 2, v1
    ds_write_b32 v20, v19
    s_and_b32 s96, s2, 7
    s_and_b32 s97, s2, 3
    s_lshr_b32 s98, s2, 3
    s_xor_b32 s98, s98, 0
    s_lshr_b32 s99, s98, 3
    s_and_b32 s100, s98, 7
    s_mov_b32 s32, 1048576
    s_cmp_ge_u32 s3, 4
    s_cbranch_scc1 LOADER

    ds_write2_b32 v19, v19, v19 offset0:8 offset1:9
    s_mov_b32 s36, 0x3f80
    s_mov_b32 s37, 0x3f800000
    s_mov_b32 s38, 0x3f803f80
    v_mov_b32 v56, s38
    s_and_b32 s58, s3, 1
    s_lshl_b32 s58, s58, 8
    v_lshl_add_u32 v58, v63, 2, s58
    ds_write_b32 v58, v56 offset:1024
    v_and_b32 v62, 15, v63
    v_lshrrev_b32 v61, 4, v63
    v_and_b32 v60, 7, v63
    v_bfe_u32 v59, v63, 3, 1
    v_lshrrev_b32 v51, 5, v63
    v_and_b32 v47, 31, v63
    v_and_b32 v57, 1, v63
    v_lshlrev_b32 v1, 4, v60
    v_lshl_add_u32 v1, v61, 2, v1
    v_lshlrev_b32 v46, 5, v63
    v_and_b32 v49, 63, v1
    v_lshrrev_b32 v49, 1, v49
    v_and_b32 v45, 64, v1
    v_add_u32 v49, v49, v45

    s_lshl_b32 s61, s96, 18
    s_add_u32 s61, s61, 2097152
    s_lshl_b32 s60, s35, 17
    s_add_u32 s60, s60, 131072
    s_lshr_b32 s58, s100, 1
    s_lshl_b32 s58, s58, 14
    s_add_u32 s29, s60, s58
    s_and_b32 s58, s100, 1
    s_lshl_b32 s58, s58, 12
    s_add_u32 s29, s29, s58
    s_lshl_b32 s58, s97, 2
    s_add_u32 s58, s58, s99
    s_lshl_b32 s58, s58, 2
    s_add_u32 s58, s58, s3
    s_lshl_b32 s58, s58, 6
    s_add_u32 s29, s29, s58
    s_lshl_b32 s39, s99, 2
    s_add_u32 s39, s39, s3
    s_lshl_b32 s39, s39, 7
    s_add_u32 s18, s60, s39
    s_add_u32 s18, s18, 0x10000
    s_lshl_b32 s58, s99, 1
    s_cmp_eq_u32 s58, s100
    s_cselect_b32 s34, 1, 0
    s_cmp_eq_u32 s97, 0
    s_cselect_b32 s34, s34, 0
    s_lshl_b32 s34, s34, s35

    s_lshl_b32 s16, s98, 11
    s_lshr_b32 s58, s3, 1
    s_lshl_b32 s58, s58, 10
    s_add_u32 s16, s16, s58
    s_add_u32 s16, s16, 32768
    s_lshl_b32 s58, s98, 9
    s_mov_b32 s59, 512
    s_cmp_eq_u32 s3, 2
    s_cselect_b32 s16, s58, s16
    s_cselect_b32 s59, 196608, s59
    s_add_u32 s16, s16, s61
    s_cmp_eq_u32 s3, 0
    s_cselect_b32 s16, s29, s16
    s_cselect_b32 s59, 8192, s59
    v_mul_u32_u24 v54, s59, v51
    v_lshl_add_u32 v54, v47, 4, v54
    s_lshl_b32 s17, s98, 7
    s_add_u32 s17, s17, s61
    s_add_u32 s17, s17, 16384
    v_mov_b32 v36, -1
    v_mov_b32 v37, -1
    v_mov_b32 v38, -1
    v_mov_b32 v39, -1
    v_mov_b32 v21, 1

    s_waitcnt lgkmcnt(0)

    s_add_u32 s4, s92, 0x1fffff
    s_addc_u32 s5, s93, 0
    s_and_b32 s4, s4, 0xffe00000
    s_mov_b32 s6, 0x400000
    s_mov_b32 s7, 0x00020000
    s_mov_b32 s10, 2048
    s_mov_b32 s11, 0x00020000

    s_cmp_lg_u32 s3, 0
    s_cbranch_scc1 P0
    buffer_load_dword v56, off, s[4:7], 0 sc1

P0:
    s_cmp_lg_u32 s35, 0
    s_cbranch_scc1 P1
    buffer_load_dwordx4 v[26:29], v46, s[8:11], 0 offen
    buffer_load_dwordx4 v[30:33], v46, s[8:11], 0 offen offset:16
    buffer_load_ushort v34, v49, s[8:11], s39 offen
    buffer_load_ushort v35, v49, s[8:11], s39 offen offset:32

P1:
    s_mov_b32 s90, s16
    s_mov_b32 s91, s17
    s_cmp_lg_u32 s3, 0
    s_cbranch_scc1 P2
    s_mov_b32 exec_lo, 0xffff
    s_mov_b32 exec_hi, 0xffff
    buffer_store_dwordx4 v[36:39], v54, s[4:7], s90 offen sc1
    s_mov_b64 exec, -1

    s_barrier
    ds_write_b32 v20, v21
    s_branch P3
P2:
    buffer_store_dwordx4 v[36:39], v54, s[4:7], s90 offen
    s_cmp_lg_u32 s3, 1
    s_cbranch_scc1 GC_1
    s_mov_b64 exec, 255
    buffer_store_dwordx4 v[36:39], v54, s[4:7], s91 offen
    s_mov_b64 exec, -1
GC_1:
    s_barrier
    s_branch P3
LOADER:
    s_sub_u32 s24, s3, 4
    s_lshr_b32 s25, s24, 1
    s_lshl_b32 s25, s25, 2
    s_and_b32 s58, s24, 1
    s_add_u32 s25, s25, s58
    v_lshrrev_b32 v10, 4, v63
    v_and_b32 v11, 15, v63
    v_and_b32 v12, 1, v10
    s_lshl_b32 s58, s24, 2
    v_lshl_or_b32 v12, v12, 1, s58
    v_xor_b32 v12, v12, v11
    v_lshlrev_b32 v12, 4, v12
    v_add_u32 v13, s58, v10
    v_xor_b32 v13, v13, v11
    v_lshlrev_b32 v13, 4, v13
    s_lshl_b32 s58, s99, 6
    s_add_u32 s58, s58, s25
    s_lshl_b32 s59, s58, 15
    s_lshl_b32 s60, s97, 3
    s_add_u32 s60, s60, s100
    s_lshl_b32 s60, s60, 8
    s_add_u32 s59, s59, s60
    v_lshl_add_u32 v2, v10, 13, v12
    v_add_u32 v2, s59, v2

    s_lshl_b32 s59, s97, 8
    s_add_u32 s58, s58, s59
    s_lshl_b32 s58, s58, 13
    s_lshl_b32 s59, s100, 8
    s_add_u32 s58, s58, s59
    v_lshl_add_u32 v5, v10, 11, v12
    v_add_u32 v5, s58, v5
    s_lshl_b32 s58, s97, 24
    s_lshl_b32 s59, s98, 15
    s_add_u32 s58, s58, s59
    s_add_u32 s58, s58, 15728640
    s_lshl_b32 s59, s25, 10
    s_add_u32 s59, s59, s58
    v_lshl_add_u32 v4, v10, 8, v12
    v_add_u32 v4, s59, v4
    s_lshl_b32 s59, s24, 10
    s_add_u32 s59, s59, s58
    v_lshl_add_u32 v3, v10, 8, v13
    v_add_u32 v3, s59, v3
    s_mov_b32 s29, 0
    s_mov_b32 s30, 0
    s_waitcnt lgkmcnt(0)
    s_mov_b32 s8, s88
    s_mov_b32 s9, s89
    s_mov_b32 s10, 0x800000
    s_mov_b32 s11, 0x00020000
    s_mov_b32 s12, s84
    s_mov_b32 s13, s85
    s_mov_b32 s14, 0x4000000
    s_mov_b32 s15, 0x00020000
    s_mov_b32 s16, s86
    s_mov_b32 s17, s87
    s_mov_b32 s18, 0x4000000
    s_mov_b32 s19, 0x00020000
    s_mov_b32 s20, s90
    s_mov_b32 s21, s91
    s_mov_b32 s22, 0x800000
    s_mov_b32 s23, 0x00020000

    s_cmp_eq_u32 s35, 0
    s_cselect_b32 s31, 4, 2
    s_cselect_b32 s59, 4, 2
    s_lshr_b32 s58, s8, 8
    s_add_u32 s58, s58, s100
    s_and_b32 s58, s58, 3
    s_cmp_eq_u32 s58, 1
    s_cselect_b32 s59, s59, 0
    s_add_u32 s31, s31, s59

    s_lshl_b32 s28, s25, 10
    s_add_u32 s28, s28, 8192
    s_mov_b32 s26, 0
    s_barrier
    s_mov_b32 m0, s28
    s_add_u32 s27, s26, 65536
    buffer_load_dwordx4 v2, s[8:11], s26 offen nt lds
    s_add_u32 m0, s28, 2048
    s_add_u32 s26, s26, 262144
    buffer_load_dwordx4 v2, s[8:11], s27 offen nt lds

    s_add_u32 s28, s28, 8192
    s_add_u32 s29, s29, 2
    s_sub_i32 s58, s29, s31
    s_max_i32 s30, s30, s58
    v_mov_b32 v6, s30

    s_cmp_eq_u32 s31, 8
    s_cbranch_scc1 LS_74
    s_cmp_eq_u32 s31, 4
    s_cbranch_scc1 LS_73
    s_waitcnt vmcnt(2)
LS_73:
    s_waitcnt vmcnt(4)
LS_74:
    s_waitcnt vmcnt(8)
    ds_write_b32 v20, v6
LL_75:
    s_mov_b32 m0, s28
    s_add_u32 s27, s26, 65536
    buffer_load_dwordx4 v2, s[8:11], s26 offen nt lds
    s_add_u32 m0, s28, 2048
    s_add_u32 s26, s26, 262144
    buffer_load_dwordx4 v2, s[8:11], s27 offen nt lds

    s_add_u32 s28, s28, 8192
    s_add_u32 s29, s29, 2
    s_sub_i32 s58, s29, s31
    s_max_i32 s30, s30, s58
    v_mov_b32 v6, s30

    s_cmp_eq_u32 s31, 8
    s_cbranch_scc1 LS_78
    s_cmp_eq_u32 s31, 4
    s_cbranch_scc1 LS_77
    s_waitcnt vmcnt(2)
LS_77:
    s_waitcnt vmcnt(4)
LS_78:
    s_waitcnt vmcnt(8)
    ds_write_b32 v20, v6
    s_cmp_lt_u32 s26, 2097152
    s_cbranch_scc1 LL_75
    s_cmp_eq_u32 s35, 0
    s_cselect_b32 s31, 4, 2
    s_lshl_b32 s28, s24, 10
    s_add_u32 s28, s28, 73728
    s_mov_b32 s26, 0
LL_79:
    s_mov_b32 m0, s28
    s_add_u32 s27, s26, 4096
    buffer_load_dwordx4 v3, s[12:15], s26 offen nt lds
    s_add_u32 m0, s28, 4096
    s_add_u32 s26, s26, 8192
    buffer_load_dwordx4 v3, s[12:15], s27 offen nt lds

    s_add_u32 s28, s28, 8192
    s_add_u32 s29, s29, 2
    s_sub_i32 s58, s29, s31
    s_max_i32 s30, s30, s58
    v_mov_b32 v6, s30

    s_cmp_eq_u32 s31, 4
    s_cbranch_scc1 LS_81
    s_waitcnt vmcnt(2)
LS_81:
    s_waitcnt vmcnt(4)
    ds_write_b32 v20, v6
    s_cmp_lt_u32 s26, 32768
    s_cbranch_scc1 LL_79
    s_cmp_eq_u32 s35, 0
    s_cselect_b32 s31, 4, 2
    s_lshl_b32 s28, s25, 10
    s_add_u32 s28, s28, 106496
    s_mov_b32 s26, 0
LL_82:
    s_mov_b32 m0, s28
    s_add_u32 s27, s26, 2048
    buffer_load_dwordx4 v4, s[16:19], s26 offen nt lds
    s_add_u32 m0, s28, 2048
    s_add_u32 s26, s26, 8192
    buffer_load_dwordx4 v4, s[16:19], s27 offen nt lds

    s_add_u32 s28, s28, 8192
    s_add_u32 s29, s29, 2
    s_sub_i32 s58, s29, s31
    s_max_i32 s30, s30, s58
    v_mov_b32 v6, s30

    s_cmp_eq_u32 s31, 4
    s_cbranch_scc1 LS_84
    s_waitcnt vmcnt(2)
LS_84:
    s_waitcnt vmcnt(4)
    ds_write_b32 v20, v6
    s_cmp_lt_u32 s26, 32768
    s_cbranch_scc1 LL_82
LWC:
    ds_read_b128 v[10:13], v19 offset:0
    s_waitcnt lgkmcnt(0)
    v_min3_u32 v10, v10, v11, v12
    v_min_u32 v10, v10, v13
    v_cmp_gt_u32 vcc, 2, v10

    s_cbranch_vccz LWD
    s_sub_u32 s32, s32, 1
    s_cbranch_scc0 LWC
    s_branch FAIL
LWD:
    s_cmp_eq_u32 s35, 0
    s_cselect_b32 s31, 4, 4
    s_cselect_b32 s59, 4, 2
    s_lshr_b32 s58, s20, 8
    s_add_u32 s58, s58, s100
    s_and_b32 s58, s58, 3
    s_cmp_eq_u32 s58, 1
    s_cselect_b32 s59, s59, 0
    s_add_u32 s31, s31, s59

    s_lshl_b32 s28, s25, 10
    s_add_u32 s28, s28, 8192
    s_mov_b32 s26, 0
LL_85:
    s_mov_b32 m0, s28
    s_add_u32 s27, s26, 16384
    buffer_load_dwordx4 v5, s[20:23], s26 offen nt lds
    s_add_u32 m0, s28, 2048
    s_add_u32 s26, s26, 65536
    buffer_load_dwordx4 v5, s[20:23], s27 offen nt lds

    s_add_u32 s28, s28, 8192
    s_add_u32 s29, s29, 2
    s_sub_i32 s58, s29, s31
    s_max_i32 s30, s30, s58
    v_mov_b32 v6, s30

    s_cmp_eq_u32 s31, 8
    s_cbranch_scc1 LS_88
    s_cmp_eq_u32 s31, 6
    s_cbranch_scc1 LS_87
    s_waitcnt vmcnt(4)
LS_87:
    s_waitcnt vmcnt(6)
LS_88:
    s_waitcnt vmcnt(8)
    ds_write_b32 v20, v6
    s_cmp_lt_u32 s26, 524288
    s_cbranch_scc1 LL_85
    s_max_i32 s30, s30, 44
    v_mov_b32 v6, s30
    s_waitcnt vmcnt(4)
    ds_write_b32 v20, v6
    s_max_i32 s30, s30, 48
    v_mov_b32 v6, s30
    s_waitcnt vmcnt(0)
    ds_write_b32 v20, v6
    s_waitcnt lgkmcnt(0)
FAIL:
EXIT:
    s_endpgm
P3:
    v_lshrrev_b32 v58, 3, v63
    v_bfe_u32 v17, v63, 1, 1
    v_lshl_or_b32 v17, v61, 1, v17
    v_lshlrev_b32 v17, 4, v17
    v_lshlrev_b32 v0, 8, v58
    v_lshl_add_u32 v0, v60, 4, v0
    v_lshl_add_u32 v2, v59, 13, v1
    v_and_b32 v58, 1, v61
    v_lshlrev_b32 v18, 13, v58
    v_lshl_add_u32 v18, v62, 2, v18
    v_lshrrev_b32 v3, 1, v60
    v_lshlrev_b32 v3, 5, v3
    v_lshl_add_u32 v3, v58, 4, v3
    v_mul_u32_u24 v9, 1152, v58
    v_lshl_add_u32 v3, v57, 3, v3
    v_lshl_add_u32 v3, v51, 2, v3
    s_lshl_b32 s58, s3, 7
    s_add_u32 s58, s58, 512
    v_add_u32 v3, s58, v3
    v_lshlrev_b32 v4, 5, v61
    v_lshl_add_u32 v4, v57, 4, v4
    v_lshl_add_u32 v4, v59, 9, v4
    v_add_u32 v4, 512, v4
    v_mov_b32 v5, 0xaaaaaaaa
    v_mul_lo_u32 v5, v5, v57
    v_add_u32 v5, 0x44444444, v5
    v_mul_u32_u24 v6, 196608, v51
    v_lshl_add_u32 v6, v47, 2, v6
    v_lshlrev_b32 v7, 4, v63
    v_lshlrev_b32 v8, 11, v51
    v_lshl_add_u32 v8, v47, 4, v8
    v_bfe_u32 v58, v63, 2, 2
    v_mul_u32_u24 v58, 288, v58
    v_add_u32 v9, v9, v58
    v_lshl_add_u32 v9, v51, 5, v9
    v_and_b32 v58, 3, v63
    v_lshl_add_u32 v9, v58, 2, v9
    s_lshl_b32 s58, s3, 6
    s_add_u32 s58, s58, 2048
    v_add_u32 v9, s58, v9
    v_mul_u32_u24 v10, 288, v61
    v_lshl_add_u32 v10, v62, 4, v10
    v_add_u32 v10, 2048, v10
    v_lshlrev_b32 v12, 5, v61
    v_add_u32 v12, 128, v12
    v_lshl_add_u32 v11, v59, 4, v12
    v_add_u32 v11, v11, v20
    v_mul_u32_u24 v13, 288, v59
    v_lshl_add_u32 v13, v61, 6, v13
    v_lshl_add_u32 v13, v57, 4, v13
    v_bfe_u32 v58, v63, 1, 2
    v_lshl_add_u32 v13, v58, 2, v13
    s_mul_i32 s58, s3, 576
    s_add_u32 s58, s58, 4352
    v_add_u32 v13, s58, v13
    v_lshlrev_b32 v14, 8, v61
    v_lshl_add_u32 v14, v57, 7, v14
    v_and_b32 v15, 14, v63
    v_lshlrev_b32 v15, 6, v15
    v_lshlrev_b32 v16, 14, v61
    v_lshl_add_u32 v16, v62, 2, v16

    s_mov_b32 s14, 2048
    s_mov_b32 s15, 0x00020000
    s_lshl_b32 s58, s99, 14
    s_lshr_b32 s59, s3, 1
    s_lshl_b32 s16, s59, 12
    s_add_u32 s16, s16, s58
    s_and_b32 s58, s3, 1
    s_lshl_b32 s58, s58, 7
    s_add_u32 s16, s16, s58
    s_add_u32 s16, s16, s60
    s_add_u32 s16, s16, 4294836224
    s_add_u32 s17, s18, 4294836224

    s_lshl_b32 s27, s99, 1
    s_add_u32 s27, s27, s59
    s_lshl_b32 s24, s27, 7

    s_add_u32 s24, s24, s61
    s_add_u32 s24, s24, 17408
    s_lshl_b32 s27, s27, 13
    s_add_u32 s27, s27, s58
    s_add_u32 s27, s27, s61
    s_add_u32 s27, s27, 32768
    s_add_u32 s28, s27, 4096

    s_lshl_b32 s19, s100, 11
    s_add_u32 s19, s19, s39
    s_add_u32 s19, s19, s61
    s_lshl_b32 s21, s100, 7
    s_add_u32 s21, s21, s61
    s_add_u32 s21, s21, 16384
    s_lshr_b32 s58, s39, 4
    s_add_u32 s20, s21, s58
    s_add_u32 s21, s61, 16384

    s_lshl_b32 s22, s3, 12
    s_add_u32 s22, s22, s61
    s_add_u32 s30, s22, 196608
    s_lshl_b32 s23, s100, 2
    s_add_u32 s23, s23, s99
    s_lshl_b32 s23, s23, 2

    s_bfe_u32 s23, s98, 0x20002
    s_lshl_b32 s23, s23, 1
    s_and_b32 s58, s98, 1
    s_or_b32 s23, s23, s58
    s_lshl_b32 s23, s23, 1
    s_lshr_b32 s58, s98, 4
    s_or_b32 s23, s23, s58
    s_lshl_b32 s23, s23, 1
    s_bfe_u32 s58, s98, 0x10001
    s_or_b32 s23, s23, s58
    s_lshl_b32 s23, s23, 2
    s_add_u32 s23, s23, s61
    s_add_u32 s23, s23, 17408
    s_lshl_b32 s25, s98, 2
    s_add_u32 s25, s25, s3
    s_lshl_b32 s25, s25, 6
    s_add_u32 s25, s25, s61
    s_add_u32 s25, s25, 32768
    s_add_u32 s26, s25, 8192
    s_mov_b32 s33, 0

    s_lshl_b32 s58, s2, 2
    s_add_u32 s58, s58, s3
    s_lshr_b32 s93, s58, 6
    s_lshl_b32 s93, s93, 14
    s_and_b32 s58, s58, 63
    s_lshl_b32 s58, s58, 7
    s_add_u32 s93, s93, s58
    s_add_u32 s93, s93, 655360

    s_mov_b32 s2, 0
    s_mov_b32 s40, 0xffffffff
    s_mov_b32 s41, 0xffffffff
    s_mov_b32 s42, 0xffffffff
    s_mov_b32 s43, 0x0
    s_mov_b32 s46, 0x30003
    s_mov_b32 s47, 0x30003
    s_mov_b32 s48, 0x5555
    s_mov_b32 s49, 0x0
    s_mov_b32 s50, 0x0
    s_mov_b32 s51, 0x80000000
    s_mov_b32 s52, 0xffff0000
    s_mov_b32 s53, 0xffff0000
    s_mov_b32 s54, 0xaaaaaaaa
    s_mov_b32 s55, 0xaaaaaaaa
    s_lshr_b32 s58, s100, 1
    s_lshl_b32 s58, s58, 2
    s_and_b32 s59, s100, 1
    s_add_u32 s58, s58, s59
    s_lshl_b32 s58, s58, 2
    s_lshl_b64 s[50:51], 1, s58
    s_cmp_eq_u32 s3, 2
    s_cselect_b64 s[86:87], s[42:43], -1
    s_cmp_eq_u32 s35, 0
    s_cselect_b32 s44, -1, 0
    s_mov_b32 s45, -1
    s_lshl_b32 s85, s96, 9
    s_add_u32 s85, s85, 32768
    v_lshl_add_u32 v53, v47, 4, s85

    s_cmp_eq_u32 s3, 0
    s_cbranch_scc1 HS0
    s_waitcnt vmcnt(0)
    ds_write_b32 v20, v21
    s_cmp_eq_u32 s3, 1
    s_cbranch_scc1 PAD_BW
    s_cmp_eq_u32 s3, 2
    s_cbranch_scc1 PAD_CM
    s_cmp_eq_u32 s3, 3
    s_cbranch_scc1 PAD_O0
PADRET:
    s_branch NOHS
HS0:
    s_getreg_b32 s89, hwreg(HW_REG_XCC_ID, 0, 4)
    s_lshl_b32 s59, s98, 4
    s_add_u32 s85, s85, s59
    s_lshl_b32 s59, s35, 2
    s_lshr_b32 s60, s100, 1
    s_add_u32 s59, s59, s60
    s_lshl_b32 s59, s59, 2
    s_add_u32 s59, s59, s97
    s_lshl_b32 s59, s59, 2
    s_add_u32 s59, s59, s99
    s_lshl_b32 s59, s59, 1
    s_and_b32 s60, s100, 1
    s_add_u32 s59, s59, s60
    s_lshl_b32 s59, s59, 4
    s_add_u32 s59, s59, 40960
    s_waitcnt vmcnt(1)
    v_readfirstlane_b32 s58, v56
    s_mul_i32 s62, s58, 0x9e3779b1
    s_add_u32 s62, s62, 0x7f4a7c15

HS_2:
    ds_read_b128 v[56:59], v19 offset:0
    s_waitcnt lgkmcnt(0)
    v_min3_u32 v56, v56, v57, v58
    v_min_u32 v56, v56, v59
    v_cmp_gt_u32 vcc, 1, v56
    s_cbranch_vccnz RT_3

    s_add_u32 s58, s62, 0
    v_mov_b32 v40, s58
    v_mov_b32 v41, s89
    s_mov_b64 exec, 1
    buffer_store_dwordx2 v[40:41], off, s[4:7], s85 sc1
    s_mov_b64 exec, -1
    s_cmp_eq_u32 s34, 0
    s_cbranch_scc1 HS1
    buffer_store_dwordx4 v[36:39], v54, s[4:7], s18 offen sc1
HS1:
    s_waitcnt vmcnt(0)
    s_mov_b64 exec, 1
    buffer_store_dword v40, off, s[4:7], s59 sc1
    s_mov_b64 exec, -1

NOHS:
    v_mov_b32 v21, 2
    s_cmp_lg_u32 s35, 0
    s_cbranch_scc1 NOX
    v_lshl_or_b32 v42, v35, 16, v34
    v_dot2_f32_bf16 v36, v26, s38, 0
    v_dot2_f32_bf16 v37, v26, v26, 0
    v_dot2_f32_bf16 v36, v27, s38, v36
    v_dot2_f32_bf16 v37, v27, v27, v37
    v_dot2_f32_bf16 v36, v28, s38, v36
    v_dot2_f32_bf16 v37, v28, v28, v37
    v_dot2_f32_bf16 v36, v29, s38, v36
    v_dot2_f32_bf16 v37, v29, v29, v37
    v_dot2_f32_bf16 v36, v30, s38, v36
    v_dot2_f32_bf16 v37, v30, v30, v37
    v_dot2_f32_bf16 v36, v31, s38, v36
    v_dot2_f32_bf16 v37, v31, v31, v37
    v_dot2_f32_bf16 v36, v32, s38, v36
    v_dot2_f32_bf16 v37, v32, v32, v37
    v_dot2_f32_bf16 v36, v33, s38, v36
    v_dot2_f32_bf16 v37, v33, v33, v37
    s_nop 1
    v_add_f32_dpp v36, v36, v36 row_ror:8 row_mask:0xf bank_mask:0xf
    v_add_f32_dpp v37, v37, v37 row_ror:8 row_mask:0xf bank_mask:0xf
    s_nop 0
    v_add_f32_dpp v36, v36, v36 row_ror:4 row_mask:0xf bank_mask:0xf
    v_add_f32_dpp v37, v37, v37 row_ror:4 row_mask:0xf bank_mask:0xf
    s_nop 0
    v_add_f32_dpp v36, v36, v36 row_ror:2 row_mask:0xf bank_mask:0xf
    v_add_f32_dpp v37, v37, v37 row_ror:2 row_mask:0xf bank_mask:0xf
    s_nop 0
    v_add_f32_dpp v36, v36, v36 row_ror:1 row_mask:0xf bank_mask:0xf
    v_add_f32_dpp v37, v37, v37 row_ror:1 row_mask:0xf bank_mask:0xf
    s_nop 0
    v_add_f32_dpp v36, v36, v36 row_bcast:15 row_mask:0xa bank_mask:0xf
    v_add_f32_dpp v37, v37, v37 row_bcast:15 row_mask:0xa bank_mask:0xf
    s_nop 0
    v_add_f32_dpp v36, v36, v36 row_bcast:31 row_mask:0xc bank_mask:0xf
    v_add_f32_dpp v37, v37, v37 row_bcast:31 row_mask:0xc bank_mask:0xf
    v_mul_f32 v36, 0x3a800000, v36
    v_mov_b32 v38, 0x3727c5ac
    v_readlane_b32 s58, v36, 63
    v_fmac_f32 v38, 0x3a800000, v37
    v_fma_f32 v38, -v36, v36, v38
    v_rsq_f32 v38, v38
    v_lshlrev_b32 v34, 16, v34
    v_lshlrev_b32 v35, 16, v35
    v_mul_f32 v38, 0x3e0293ee, v38
    v_subrev_f32 v34, s58, v34
    v_subrev_f32 v35, s58, v35
    v_readlane_b32 s84, v38, 63
    v_cvt_pk_bf16_f32 v43, v34, v35
    ds_write_b32 v3, v43

NOX:
    v_mbcnt_lo_u32_b32 v28, -1, 0
    v_mbcnt_hi_u32_b32 v28, -1, v28
    v_bfe_u32 v29, v28, 2, 1
    v_bfe_u32 v30, v28, 3, 1
    v_lshrrev_b32 v31, 4, v28
    v_lshlrev_b32 v26, 4, v29
    v_lshl_add_u32 v26, v31, 2, v26
    v_add_u32 v26, v26, v30
    v_lshlrev_b32 v26, 8, v26
    v_and_b32 v31, 1, v31
    v_lshl_or_b32 v30, v31, 1, v30
    v_lshl_or_b32 v30, v29, 2, v30
    s_lshl_b32 s58, s3, 1
    v_xor_b32 v30, s58, v30
    v_lshl_add_u32 v26, v30, 5, v26
    v_and_b32 v28, 3, v28
    v_lshl_add_u32 v26, v28, 3, v26
    v_add_u32 v26, 8192, v26
    v_xor_b32 v27, 32, v26

    v_mov_b32 v55, v26
    v_mov_b32 v44, 0
    v_mov_b32 v45, 0
    v_mov_b32 v46, 0
    v_mov_b32 v47, 0
    v_mov_b32 v48, 0
    v_mov_b32 v49, 0
    v_mov_b32 v50, 0
    v_mov_b32 v51, 0
WL_4:
    ds_read_b128 v[56:59], v19 offset:16
    s_waitcnt lgkmcnt(0)
    v_min3_i32 v56, v56, v57, v58
    v_min_i32 v56, v56, v59
    v_cmp_gt_i32 vcc, 4, v56
    s_cbranch_vccnz RT_5
    ds_read_b64_tr_b16 a[0:1], v26 offset:0
    ds_read_b64_tr_b16 a[2:3], v26 offset:512
    ds_read_b64_tr_b16 a[4:5], v26 offset:8192
    ds_read_b64_tr_b16 a[6:7], v26 offset:8704
    ds_read_b64_tr_b16 a[8:9], v27 offset:0
    ds_read_b64_tr_b16 a[10:11], v27 offset:512
    ds_read_b64_tr_b16 a[12:13], v27 offset:8192
    ds_read_b64_tr_b16 a[14:15], v27 offset:8704
WL_6:
    ds_read_b128 v[56:59], v19 offset:16
    s_waitcnt lgkmcnt(0)
    v_min3_i32 v56, v56, v57, v58
    v_min_i32 v56, v56, v59
    v_cmp_gt_i32 vcc, 8, v56
    s_cbranch_vccnz RT_7
    s_cmp_lg_u32 s3, 0
    s_cbranch_scc1 NP_8
    buffer_load_dwordx2 v[22:23], v53, s[4:7], 0 offen sc1
NP_8:
    ds_read_b64_tr_b16 a[16:17], v26 offset:16384
    ds_read_b64_tr_b16 a[18:19], v26 offset:16896
    ds_read_b64_tr_b16 a[20:21], v26 offset:24576
    ds_read_b64_tr_b16 a[22:23], v26 offset:25088
    ds_read_b64_tr_b16 a[24:25], v27 offset:16384
    ds_read_b64_tr_b16 a[26:27], v27 offset:16896
    ds_read_b64_tr_b16 a[28:29], v27 offset:24576
    ds_read_b64_tr_b16 a[30:31], v27 offset:25088
WL_9:
    ds_read_b128 v[56:59], v19 offset:16
    s_waitcnt lgkmcnt(0)
    v_min3_i32 v56, v56, v57, v58
    v_min_i32 v56, v56, v59
    v_cmp_gt_i32 vcc, 12, v56
    s_cbranch_vccnz RT_10
    s_cmp_lg_u32 s3, 0
    s_cbranch_scc1 NP_11
    buffer_load_dwordx2 v[24:25], v53, s[4:7], 0 offen sc1
NP_11:
    ds_read_b64_tr_b16 a[32:33], v26 offset:32768
    ds_read_b64_tr_b16 a[34:35], v26 offset:33280
    ds_read_b64_tr_b16 a[36:37], v26 offset:40960
    ds_read_b64_tr_b16 a[38:39], v26 offset:41472
    ds_read_b64_tr_b16 a[40:41], v27 offset:32768
    ds_read_b64_tr_b16 a[42:43], v27 offset:33280
    ds_read_b64_tr_b16 a[44:45], v27 offset:40960
    ds_read_b64_tr_b16 a[46:47], v27 offset:41472
WL_12:
    ds_read_b128 v[56:59], v19 offset:16
    s_waitcnt lgkmcnt(0)
    v_min3_i32 v56, v56, v57, v58
    v_min_i32 v56, v56, v59
    v_cmp_gt_i32 vcc, 16, v56
    s_cbranch_vccnz RT_13
    ds_read_b64_tr_b16 a[48:49], v26 offset:49152
    ds_read_b64_tr_b16 a[50:51], v26 offset:49664
    ds_read_b64_tr_b16 a[52:53], v26 offset:57344
    ds_read_b64_tr_b16 a[54:55], v26 offset:57856
    ds_read_b64_tr_b16 a[56:57], v27 offset:49152
    ds_read_b64_tr_b16 a[58:59], v27 offset:49664
    ds_read_b64_tr_b16 a[60:61], v27 offset:57344
    ds_read_b64_tr_b16 a[62:63], v27 offset:57856
    s_waitcnt lgkmcnt(0)
    ds_write_b32 v20, v21
    ds_read_b128 v[56:59], v19 offset:0
    ds_read_b128 v[26:29], v4 offset:0
    ds_read_b128 v[30:33], v4 offset:128
    ds_read_b128 v[34:37], v4 offset:256
    ds_read_b128 v[38:41], v4 offset:384
SC_15:
    s_waitcnt lgkmcnt(4)
    v_min3_u32 v56, v56, v57, v58
    v_min_u32 v56, v56, v59
    v_cmp_gt_u32 vcc, v21, v56
    s_cbranch_vccnz SY_14
    v_add_u32 v21, 1, v21
    s_waitcnt lgkmcnt(3)
    v_smfmac_f32_16x16x64_bf16 v[44:47], v[26:29], a[0:7], v5
    v_smfmac_f32_16x16x64_bf16 v[48:51], v[26:29], a[8:15], v5
    s_waitcnt lgkmcnt(2)
    v_smfmac_f32_16x16x64_bf16 v[44:47], v[30:33], a[16:23], v5
    v_smfmac_f32_16x16x64_bf16 v[48:51], v[30:33], a[24:31], v5
    s_waitcnt lgkmcnt(1)
    v_smfmac_f32_16x16x64_bf16 v[44:47], v[34:37], a[32:39], v5
    v_smfmac_f32_16x16x64_bf16 v[48:51], v[34:37], a[40:47], v5
    s_waitcnt lgkmcnt(0)
    v_smfmac_f32_16x16x64_bf16 v[44:47], v[38:41], a[48:55], v5
    v_smfmac_f32_16x16x64_bf16 v[48:51], v[38:41], a[56:63], v5
    s_cmp_lg_u32 s3, 0
    s_cbranch_scc1 WM
HP0:
    s_waitcnt vmcnt(1)
    v_subrev_u32 v22, s62, v22
    v_cmp_lt_u32 vcc, 1, v22

    v_mov_b32 v52, v23
    s_cbranch_vccz HPOK
HP1:
    s_waitcnt vmcnt(0)
    v_subrev_u32 v24, s62, v24
    v_cmp_lt_u32 vcc, 1, v24

    v_mov_b32 v52, v25
    s_cbranch_vccnz HPR
HPOK:
    v_cmp_ne_u32 vcc, s89, v52
    s_nop 3
    s_cmp_eq_u32 vcc_lo, 0
    s_cselect_b32 s58, 2, 3
    v_mov_b32 v52, s58
    ds_write_b32 v19, v52 offset:32

WM:
    ds_read_b32 v56, v19 offset:32
    s_waitcnt lgkmcnt(0)
    v_cmp_eq_u32 vcc, 0, v56
    s_cbranch_vccnz RT_16
    v_readfirstlane_b32 s31, v56
    v_add_f32 v44, v44, v45
    v_add_f32 v48, v48, v49
    v_cndmask_b32 v44, v44, v48, s[52:53]
    s_cmp_lg_u32 s31, 2
    s_cbranch_scc1 SLOWCLR

WM2:
    s_mov_b64 exec, s[44:45]
    s_cmp_eq_u32 s31, 1
    s_cbranch_scc1 SS_22
    buffer_store_dword v44, v6, s[4:7], s19 offen
SB_23:
    s_mov_b64 exec, -1
    s_mov_b64 s[44:45], s[42:43]
    v_mov_b32 v36, -1
    v_mov_b32 v37, -1
    v_mov_b32 v38, -1
    v_mov_b32 v39, -1
    s_cmp_eq_u32 s3, 0
    s_cbranch_scc1 DC0
    s_add_u32 s58, s90, 98304
    s_add_u32 s59, s91, 98304
    s_mov_b64 exec, s[86:87]
    s_cmp_eq_u32 s31, 1
    s_cbranch_scc1 SS_24
    buffer_store_dwordx4 v[36:39], v54, s[4:7], s58 offen
SB_25:
    buffer_load_dwordx4 v[48:51], v54, s[4:7], s58 offen sc1
    s_cmp_eq_u32 s35, 0
    s_cbranch_scc1 DP_26
    buffer_load_dwordx4 v[48:51], v54, s[4:7], s90 offen sc1
DP_26:
    s_cmp_lg_u32 s3, 1
    s_cbranch_scc1 DC1
    s_mov_b64 exec, 255
    s_cmp_eq_u32 s31, 1
    s_cbranch_scc1 SS_27
    buffer_store_dwordx4 v[36:39], v54, s[4:7], s59 offen
SB_28:
    buffer_load_dwordx4 v[48:51], v54, s[4:7], s59 offen sc1
    s_cmp_eq_u32 s35, 0
    s_cbranch_scc1 DP_29
    buffer_load_dwordx4 v[48:51], v54, s[4:7], s91 offen sc1
DP_29:
    s_branch DC1
DC0:
    s_add_u32 s58, s90, 0x40000
    s_add_u32 s59, s18, 0x40000
    s_mov_b32 exec_lo, 0xffff
    s_mov_b32 exec_hi, 0xffff
    buffer_store_dwordx4 v[36:39], v54, s[4:7], s58 offen sc1
    s_mov_b64 exec, -1
    s_cmp_eq_u32 s34, 0
    s_cbranch_scc1 DC1
    buffer_store_dwordx4 v[36:39], v54, s[4:7], s59 offen sc1

DC1:
    s_mov_b64 exec, -1
    s_cmp_lg_u32 s35, 0
    s_cbranch_scc1 BFIRST
    s_cmp_eq_u32 s34, 0
    s_cbranch_scc1 NORES0
    buffer_store_dword v42, v2, s[4:7], s18 offen sc1
NORES0:
    buffer_load_dwordx4 v[28:31], v8, s[4:7], s22 offen offset:0 sc1
    buffer_load_dwordx4 v[32:35], v8, s[4:7], s22 offen offset:512 sc1
    buffer_load_dwordx4 v[36:39], v8, s[4:7], s22 offen offset:1024 sc1
    buffer_load_dwordx4 v[40:43], v8, s[4:7], s22 offen offset:1536 sc1
    s_cmp_ge_u32 s2, 1
    s_cbranch_scc1 BG2
    s_mov_b32 s101, 1
    s_call_b64 s[0:1], LD
BG2:
    s_mov_b32 s59, s84
    v_mov_b32 v60, 0
    v_mov_b32 v61, 0
    v_mov_b32 v62, 0
    v_mov_b32 v63, 0
    s_waitcnt vmcnt(4)
    v_mov_b32 v44, 0
    v_mov_b32 v45, 0
    v_mov_b32 v46, 0
    v_mov_b32 v47, 0
    v_mov_b32 v48, 0
    v_mov_b32 v49, 0
    v_mov_b32 v50, 0
    v_mov_b32 v51, 0
    s_branch BQ2
BFIRST:
    s_cmp_eq_u32 s3, 3
    s_cbranch_scc1 PAD_S0
SPADRET:
    s_cmp_lg_u32 s3, 0
    s_cbranch_scc1 RX1
    s_xor_b32 s59, s35, 1
    s_lshl_b32 s59, s59, 2
    s_add_u32 s59, s59, s99
    s_lshl_b32 s59, s59, 9
    s_add_u32 s59, s59, 40960
    v_and_b32 v26, 0x1f0, v8

RX0:
    buffer_load_dword v27, v26, s[4:7], s59 offen sc1
    s_waitcnt vmcnt(0)
    v_cmp_ne_u32 vcc, s62, v27
    s_cbranch_vccnz RT_30

RX1:
    ds_write_b32 v20, v21
CSG_31:
    buffer_load_dwordx4 v[26:29], v8, s[4:7], s30 offen offset:0 sc1
    buffer_load_dwordx4 v[30:33], v8, s[4:7], s30 offen offset:512 sc1
    buffer_load_dwordx4 v[34:37], v8, s[4:7], s30 offen offset:1024 sc1
    buffer_load_dwordx4 v[38:41], v8, s[4:7], s30 offen offset:1536 sc1
    s_waitcnt vmcnt(0)
    v_pk_add_f32 v[22:23], v[26:27], v[30:31]
    v_pk_add_f32 v[34:35], v[34:35], v[38:39]
    v_pk_add_f32 v[24:25], v[28:29], v[32:33]
    v_pk_add_f32 v[36:37], v[36:37], v[40:41]
    v_pk_add_f32 v[22:23], v[22:23], v[34:35]
    v_pk_add_f32 v[24:25], v[24:25], v[36:37]
    v_cmp_u_f32 vcc, v22, v23
    v_cmp_u_f32 s[56:57], v24, v25
    s_nop 0
    s_or_b64 vcc, vcc, s[56:57]
    s_cbranch_vccnz RT_32
    ds_read_b128 v[56:59], v19 offset:0
SC_34:
    s_waitcnt lgkmcnt(0)
    v_min3_u32 v56, v56, v57, v58
    v_min_u32 v56, v56, v59
    v_cmp_gt_u32 vcc, v21, v56
    s_cbranch_vccnz SY_33
    v_add_u32 v21, 1, v21
    s_cmp_eq_u32 s33, 0
    s_cbranch_scc1 BW
PROBE:
    v_mbcnt_lo_u32_b32 v26, -1, 0
    v_lshlrev_b32 v26, 13, v26
    s_mov_b64 exec, 3
    buffer_store_dword v26, v26, s[4:7], s93 offen sc1
    s_mov_b64 exec, 1
    s_and_b32 s59, s3, 2
    s_lshl_b32 s58, s59, 12
    s_add_u32 s93, s93, s58
    s_xor_b32 s58, s93, 8192
    v_lshl_add_u32 v28, s59, 3, v20
    v_xor_b32 v29, 16, v28
    s_waitcnt vmcnt(0)
    s_memtime s[70:71]
    buffer_load_dword v26, off, s[4:7], s93 sc1
    s_waitcnt vmcnt(0)
    s_memtime s[72:73]
    buffer_load_dword v26, off, s[4:7], s58 sc1
    s_waitcnt vmcnt(0)
    s_memtime s[74:75]
    s_waitcnt lgkmcnt(0)
    s_sub_u32 s74, s74, s72
    s_sub_u32 s72, s72, s70
    v_mov_b32 v26, s72
    v_mov_b32 v27, s74
    ds_write_b32 v28, v26 offset:64
    ds_write_b32 v29, v27 offset:64
    s_mov_b64 exec, -1

    ds_write_b32 v20, v21
    ds_read_b128 v[56:59], v19 offset:0
    ds_read_b128 v[26:29], v19 offset:64
    ds_read_b128 v[30:33], v19 offset:80
SC_36:
    s_waitcnt lgkmcnt(2)
    v_min3_u32 v56, v56, v57, v58
    v_min_u32 v56, v56, v59
    v_cmp_gt_u32 vcc, v21, v56
    s_cbranch_vccnz SY_35
    v_add_u32 v21, 1, v21
    s_waitcnt lgkmcnt(0)
    v_min3_u32 v26, v26, v27, v28
    v_min3_u32 v30, v30, v31, v32
    v_min_u32 v26, v26, v29
    v_min_u32 v30, v30, v33
    v_cmp_lt_u32 vcc, v30, v26
    s_nop 3
    s_cmp_lg_u32 vcc_lo, 0
    s_cselect_b32 s58, 8192, 0
    s_add_u32 s16, s16, s58
    s_add_u32 s17, s17, s58

    s_cmp_eq_u32 s31, 2
    s_cbranch_scc1 LOOP_S
    s_branch LOOP
    .p2align 7
    s_nop 0
    s_nop 0
    s_nop 0
    s_nop 0
PAD_BW:
    s_branch PAD_BST
BW:
    s_cmp_ge_u32 s2, 6
    s_cbranch_scc1 BWX
    s_mov_b32 s101, 0
    s_call_b64 s[0:1], LD
    s_mov_b64 exec, 1
    buffer_load_dword v26, v0, s[4:7], s16 offen sc1
    s_waitcnt vmcnt(0)
    v_cmp_eq_u32 vcc, -1, v26
    s_mov_b64 exec, -1
    s_cbranch_vccnz RT_37

BWX:
LOOP:
APOLL:
    s_cmp_lt_u32 s2, 6
    s_cbranch_scc1 AF
    buffer_load_dwordx4 v[52:55], v0, s[4:7], s16 offen sc1
    buffer_load_dwordx4 v[56:59], v0, s[4:7], s16 offen offset:2048 sc1
    buffer_load_dword v42, v1, s[4:7], s17 offen sc1

    buffer_load_dwordx4 v[52:55], v0, s[4:7], s16 offen sc1
    buffer_load_dwordx4 v[56:59], v0, s[4:7], s16 offen offset:2048 sc1
    buffer_load_dword v42, v1, s[4:7], s17 offen sc1

    v_mov_b32 v44, s36
    v_mov_b32 v45, s37
    v_mov_b32 v46, 0x44444444
    v_mov_b32 v47, 0xeeeeeeee
    v_cndmask_b32 v44, v44, v45, s[54:55]
    v_mov_b32 v38, 0
    v_mov_b32 v39, 0
    v_mov_b32_dpp v46, v47 quad_perm:[0,1,2,3] row_mask:0xf bank_mask:0xa
    v_mov_b32_dpp v38, v44 quad_perm:[0,1,2,3] row_mask:0xf bank_mask:0x3
    v_mov_b32_dpp v39, v44 quad_perm:[0,1,2,3] row_mask:0xf bank_mask:0xc
    v_mov_b32 v34, 0
    v_mov_b32 v35, 0
    v_mov_b32 v40, v38
    v_mov_b32 v41, v39

AW:
    s_waitcnt vmcnt(5)
    v_max3_u32 v44, v52, v53, v54
    s_waitcnt vmcnt(4)
    v_max3_u32 v45, v56, v57, v58
    v_max3_u32 v44, v44, v55, v59
    v_smfmac_f32_16x16x64_bf16 v[34:37], v[38:41], v[52:59], v46
    s_waitcnt vmcnt(3)
    v_max3_u32 v44, v44, v45, v42
    v_and_b32 v45, 0xffff0000, v42
    v_cmp_eq_u32 vcc, -1, v44
    v_lshlrev_b32 v44, 16, v42
    s_cbranch_vccnz AR

AU:
    s_nop 1
    v_add_f32_dpp v34, v34, v34 row_ror:8 row_mask:0xf bank_mask:0xf
    v_add_f32_dpp v35, v35, v35 row_ror:8 row_mask:0xf bank_mask:0xf
    v_pk_add_f32 v[34:35], v[34:35], v[44:45]
    v_cvt_pk_bf16_f32 v43, v34, v35
    ds_write_b32 v3, v43

    s_cmp_eq_u32 s2, 6
    s_cselect_b32 s58, s31, 0
    s_lshr_b32 s58, s58, 1
    v_mov_b32 v50, s58
    s_mov_b64 exec, 1
    ds_add_u32 v19, v50 offset:36
    s_mov_b64 exec, -1
    ds_write_b32 v20, v21
    ds_read_b128 v[60:63], v19 offset:0
    ds_read_b32 v50, v19 offset:36
    ds_read_b128 v[26:29], v4 offset:0
    ds_read_b128 v[30:33], v4 offset:128
    ds_read_b128 v[34:37], v4 offset:256
    ds_read_b128 v[38:41], v4 offset:384
    v_dot2_f32_bf16 v46, v43, s38, 0
    v_dot2_f32_bf16 v47, v43, v43, 0
    v_mov_b32 v44, 0
    v_mov_b32 v45, 0
    v_add_f32_dpp v46, v46, v46 quad_perm:[1,0,3,2] row_mask:0xf bank_mask:0xf
    v_add_f32_dpp v47, v47, v47 quad_perm:[1,0,3,2] row_mask:0xf bank_mask:0xf
    v_mov_b32 v48, 0
    v_mov_b32 v49, 0
    v_add_f32_dpp v46, v46, v46 quad_perm:[2,3,0,1] row_mask:0xf bank_mask:0xf
    v_add_f32_dpp v47, v47, v47 quad_perm:[2,3,0,1] row_mask:0xf bank_mask:0xf
    s_mov_b64 exec, s[50:51]
    s_cmp_eq_u32 s31, 1
    s_cbranch_scc1 SS_40
    buffer_store_dwordx2 v[46:47], off, s[4:7], s20
SB_41:
    s_mov_b64 exec, s[40:41]
SC_39:
    s_waitcnt lgkmcnt(4)
    v_min3_u32 v60, v60, v61, v62
    v_min_u32 v60, v60, v63
    v_cmp_gt_u32 vcc, v21, v60
    s_cbranch_vccnz SY_38
    v_add_u32 v21, 1, v21
    v_cmp_eq_u32 vcc, 4, v50
    s_cbranch_vccnz S1GO_S
    s_waitcnt lgkmcnt(3)
    v_smfmac_f32_16x16x64_bf16 v[44:47], v[26:29], a[0:7], v5
    v_smfmac_f32_16x16x64_bf16 v[48:51], v[26:29], a[8:15], v5
    s_waitcnt lgkmcnt(2)
    v_smfmac_f32_16x16x64_bf16 v[44:47], v[30:33], a[16:23], v5
    v_smfmac_f32_16x16x64_bf16 v[48:51], v[30:33], a[24:31], v5
    s_waitcnt lgkmcnt(1)
    v_smfmac_f32_16x16x64_bf16 v[44:47], v[34:37], a[32:39], v5
    v_smfmac_f32_16x16x64_bf16 v[48:51], v[34:37], a[40:47], v5
    s_waitcnt lgkmcnt(0)
    v_smfmac_f32_16x16x64_bf16 v[44:47], v[38:41], a[48:55], v5
    v_smfmac_f32_16x16x64_bf16 v[48:51], v[38:41], a[56:63], v5
    s_nop 6
    v_add_f32 v44, v44, v45
    v_add_f32 v48, v48, v49
    v_cndmask_b32 v44, v44, v48, s[52:53]
    s_mov_b64 exec, s[44:45]

    s_cmp_eq_u32 s31, 1
    s_cbranch_scc1 SS_42
    buffer_store_dword v44, v6, s[4:7], s19 offen
SB_43:
    s_mov_b64 exec, s[40:41]
    s_cmp_lt_u32 s2, 6
    s_cbranch_scc1 BF
BST:
    buffer_load_dwordx4 v[56:59], v7, s[4:7], s21 offen sc1
    s_branch PADX_BST
PAD_BST:
    s_branch PADRET
PADX_BST:
    v_mov_b32 v44, 0
    v_mov_b32 v45, 0
    v_mov_b32 v46, 0
    v_mov_b32 v47, 0
    v_mov_b32 v48, 0
    v_mov_b32 v49, 0
    v_mov_b32 v50, 0
    v_mov_b32 v51, 0
    s_waitcnt vmcnt(0)
    v_pk_add_f32 v[26:27], v[56:57], v[58:59]

    v_cmp_u_f32 vcc, v26, v27
    s_cbranch_vccnz RT_44

    buffer_load_dwordx4 v[28:31], v8, s[4:7], s22 offen offset:0 sc1
    buffer_load_dwordx4 v[32:35], v8, s[4:7], s22 offen offset:512 sc1
    buffer_load_dwordx4 v[36:39], v8, s[4:7], s22 offen offset:1024 sc1
    buffer_load_dwordx4 v[40:43], v8, s[4:7], s22 offen offset:1536 sc1
BS:
    v_add_f32_dpp v26, v26, v26 row_ror:8 row_mask:0xf bank_mask:0xf
    v_add_f32_dpp v27, v27, v27 row_ror:8 row_mask:0xf bank_mask:0xf
    s_nop 0
    v_add_f32_dpp v26, v26, v26 row_ror:4 row_mask:0xf bank_mask:0xf
    v_add_f32_dpp v27, v27, v27 row_ror:4 row_mask:0xf bank_mask:0xf
    s_nop 0
    v_add_f32_dpp v26, v26, v26 row_ror:2 row_mask:0xf bank_mask:0xf
    v_add_f32_dpp v27, v27, v27 row_ror:2 row_mask:0xf bank_mask:0xf
    s_nop 0
    v_add_f32_dpp v26, v26, v26 row_ror:1 row_mask:0xf bank_mask:0xf
    v_add_f32_dpp v27, v27, v27 row_ror:1 row_mask:0xf bank_mask:0xf
    s_nop 0
    v_add_f32_dpp v26, v26, v26 row_bcast:15 row_mask:0xa bank_mask:0xf
    v_add_f32_dpp v27, v27, v27 row_bcast:15 row_mask:0xa bank_mask:0xf
    s_nop 0
    v_add_f32_dpp v26, v26, v26 row_bcast:31 row_mask:0xc bank_mask:0xf
    v_add_f32_dpp v27, v27, v27 row_bcast:31 row_mask:0xc bank_mask:0xf
    v_mul_f32 v26, 0xba800000, v26
    v_mov_b32 v54, 0x3727c5ac
    v_fmac_f32 v54, 0x3a800000, v27
    v_fma_f32 v54, -v26, v26, v54
    v_rsq_f32 v54, v54
    s_nop 0
    v_mul_f32 v54, 0x3e0293ee, v54

    v_mul_f32 v26, v26, v54
    s_nop 0
    v_readlane_b32 s58, v26, 63
    v_readlane_b32 s59, v54, 63
BQ1:
    s_nop 1
    v_pk_mul_f32 v[62:63], v[24:25], s[58:59] op_sel_hi:[1,0]
    v_pk_mul_f32 v[60:61], v[22:23], s[58:59] op_sel_hi:[1,0]

BQ2:
    s_waitcnt vmcnt(3)
    v_pk_fma_f32 v[28:29], v[28:29], s[58:59], v[60:61] op_sel:[0,1,0] op_sel_hi:[1,1,1]
    v_pk_fma_f32 v[30:31], v[30:31], s[58:59], v[62:63] op_sel:[0,1,0] op_sel_hi:[1,1,1]
    s_waitcnt vmcnt(2)
    v_pk_fma_f32 v[28:29], v[32:33], s[58:59], v[28:29] op_sel:[0,1,0] op_sel_hi:[1,1,1]
    v_pk_fma_f32 v[30:31], v[34:35], s[58:59], v[30:31] op_sel:[0,1,0] op_sel_hi:[1,1,1]
    s_waitcnt vmcnt(1)
    v_pk_fma_f32 v[28:29], v[36:37], s[58:59], v[28:29] op_sel:[0,1,0] op_sel_hi:[1,1,1]
    v_pk_fma_f32 v[30:31], v[38:39], s[58:59], v[30:31] op_sel:[0,1,0] op_sel_hi:[1,1,1]
    s_waitcnt vmcnt(0)
    v_pk_fma_f32 v[28:29], v[40:41], s[58:59], v[28:29] op_sel:[0,1,0] op_sel_hi:[1,1,1]
    v_pk_fma_f32 v[30:31], v[42:43], s[58:59], v[30:31] op_sel:[0,1,0] op_sel_hi:[1,1,1]
    v_cvt_pk_bf16_f32 v32, v28, v29
    v_cvt_pk_bf16_f32 v33, v30, v31
    ds_write2_b32 v9, v32, v33 offset1:4
    v_cmp_u_f32 vcc, v28, v29
    v_cmp_u_f32 s[56:57], v30, v31

    s_or_b64 vcc, vcc, s[56:57]
    s_cbranch_vccnz RB_45

    ds_write_b32 v20, v21
    ds_read_b128 v[56:59], v19 offset:0
    ds_read_b128 v[26:29], v10 offset:0
    ds_read_b128 v[30:33], v10 offset:1152
SC_47:
    s_waitcnt lgkmcnt(2)
    v_min3_u32 v56, v56, v57, v58
    v_min_u32 v56, v56, v59
    v_cmp_gt_u32 vcc, v21, v56
    s_cbranch_vccnz SY_46
    v_add_u32 v21, 1, v21
    s_waitcnt lgkmcnt(1)
    v_smfmac_f32_16x16x64_bf16 v[44:47], v[26:29], a[64:71], v5
    v_smfmac_f32_16x16x64_bf16 v[48:51], v[26:29], a[80:87], v5
    s_waitcnt lgkmcnt(0)
    v_smfmac_f32_16x16x64_bf16 v[44:47], v[30:33], a[72:79], v5
    v_smfmac_f32_16x16x64_bf16 v[48:51], v[30:33], a[88:95], v5
    s_nop 6
    v_add_f32 v34, v44, v45
    v_add_f32 v36, v46, v47
    v_add_f32 v35, v48, v49
    v_add_f32 v37, v50, v51
    v_max_f32 v38, v34, v35
    v_max_f32 v39, v36, v37

    s_nop 0
    v_max_f32_dpp v40, v38, v38 row_ror:8 row_mask:0xf bank_mask:0x3
    s_nop 1
    v_max_f32_dpp v40, v39, v39 row_ror:8 row_mask:0xf bank_mask:0xc
    s_nop 1
    v_max_f32_dpp v40, v40, v40 row_half_mirror row_mask:0xf bank_mask:0xf
    s_nop 1
    v_max_f32_dpp v40, v40, v40 quad_perm:[1,0,3,2] row_mask:0xf bank_mask:0xf
    s_nop 1
    v_max_f32_dpp v40, v40, v40 quad_perm:[2,3,0,1] row_mask:0xf bank_mask:0xf
    ds_write_b32 v11, v40
    ds_write_b32 v20, v21
    ds_read_b128 v[56:59], v19 offset:0
    ds_read_b128 v[26:29], v12 offset:0
    ds_read_b128 v[30:33], v12 offset:16
    v_mov_b32 v44, 0
    v_mov_b32 v45, 0
    v_mov_b32 v46, 0
    v_mov_b32 v47, 0
    v_mov_b32 v48, 0
    v_mov_b32 v49, 0
    v_mov_b32 v50, 0
    v_mov_b32 v51, 0
SC_49:
    s_waitcnt lgkmcnt(2)
    v_min3_u32 v56, v56, v57, v58
    v_min_u32 v56, v56, v59
    v_cmp_gt_u32 vcc, v21, v56
    s_cbranch_vccnz SY_48
    v_add_u32 v21, 1, v21
    s_waitcnt lgkmcnt(1)
    v_max3_f32 v26, v26, v27, v28
    v_max_f32 v26, v26, v29
    s_waitcnt lgkmcnt(0)
    v_max3_f32 v30, v30, v31, v32
    v_max_f32 v30, v30, v33

    v_pk_add_f32 v[34:35], v[34:35], v[26:27] op_sel_hi:[1,0] neg_lo:[0,1] neg_hi:[0,1]
    v_pk_add_f32 v[36:37], v[36:37], v[30:31] op_sel_hi:[1,0] neg_lo:[0,1] neg_hi:[0,1]
    v_exp_f32 v34, v34
    v_exp_f32 v35, v35
    v_exp_f32 v36, v36
    v_exp_f32 v37, v37
    v_cvt_pk_bf16_f32 v38, v34, v35
    v_cvt_pk_bf16_f32 v39, v36, v37
    ds_write2_b32 v13, v38, v39 offset1:8

    ds_write_b32 v20, v21
    ds_read_b128 v[56:59], v19 offset:0
    ds_read_b128 v[32:35], v10 offset:2304
    ds_read_b128 v[36:39], v10 offset:3456
    s_cmp_lt_u32 s2, 6
    s_cbranch_scc1 LC_52
LB_53:
SC_51:
    s_waitcnt lgkmcnt(2)
    v_min3_u32 v56, v56, v57, v58
    v_min_u32 v56, v56, v59
    v_cmp_gt_u32 vcc, v21, v56
    s_cbranch_vccnz SY_50
    v_add_u32 v21, 1, v21
    s_cmp_lg_u32 s3, 0
    s_cbranch_scc1 NM_54
    v_cndmask_b32 v40, v26, v30, s[54:55]
    s_mov_b64 exec, s[46:47]
    s_cmp_eq_u32 s31, 1
    s_cbranch_scc1 SS_55
    buffer_store_dword v40, v14, s[4:7], s23 offen
SB_56:
    s_mov_b64 exec, s[40:41]
NM_54:
    s_waitcnt lgkmcnt(1)
    v_smfmac_f32_16x16x64_bf16 v[44:47], v[32:35], a[96:103], v5
    v_smfmac_f32_16x16x64_bf16 v[48:51], v[32:35], a[104:111], v5
    s_waitcnt lgkmcnt(0)
    v_smfmac_f32_16x16x64_bf16 v[44:47], v[36:39], a[112:119], v5
    v_smfmac_f32_16x16x64_bf16 v[48:51], v[36:39], a[120:127], v5
    s_cmp_lg_u32 s3, 1
    s_cbranch_scc1 NOL
    v_dot2_f32_bf16 v40, v32, s38, 0
    v_dot2_f32_bf16 v40, v33, s38, v40
    v_dot2_f32_bf16 v40, v34, s38, v40
    v_dot2_f32_bf16 v40, v35, s38, v40
    v_dot2_f32_bf16 v40, v36, s38, v40
    v_dot2_f32_bf16 v40, v37, s38, v40
    v_dot2_f32_bf16 v40, v38, s38, v40
    v_dot2_f32_bf16 v40, v39, s38, v40
    s_nop 2
    v_add_f32_dpp v40, v40, v40 quad_perm:[1,0,3,2] row_mask:0xf bank_mask:0xf
    v_mov_b32 v41, v40
    s_nop 1
    v_permlane16_swap_b32 v40, v41
    v_add_f32 v40, v40, v41
    v_mov_b32 v41, v40
    s_nop 1
    v_permlane32_swap_b32 v40, v41
    v_add_f32 v40, v40, v41

    s_mov_b64 exec, s[48:49]
    s_cmp_eq_u32 s31, 1
    s_cbranch_scc1 SS_57
    buffer_store_dword v40, v15, s[4:7], s23 offen offset:1024
SB_58:
    s_mov_b64 exec, s[40:41]
NOL:
    s_nop 4
    v_add_f32 v44, v44, v45
    v_add_f32 v46, v46, v47
    v_add_f32 v48, v48, v49
    v_add_f32 v50, v50, v51
    v_cvt_pk_bf16_f32 v44, v44, v48
    v_cvt_pk_bf16_f32 v46, v46, v50

    s_cmp_eq_u32 s31, 1
    s_cbranch_scc1 SS_59
    buffer_store_dword v44, v16, s[4:7], s25 offen
    buffer_store_dword v46, v16, s[4:7], s26 offen
SB_60:
    s_cmp_lt_u32 s2, 6
    s_cbranch_scc1 CF
CM:
    buffer_load_dwordx4 v[26:29], v17, s[4:7], s24 offen sc1
    s_branch PADX_CM
PAD_CM:
    s_branch PAD_LAST
PADX_CM:
    s_waitcnt vmcnt(0)
    v_pk_add_f32 v[50:51], v[26:27], v[28:29]
    v_cmp_u_f32 vcc, v50, v51
    s_cbranch_vccnz RT_61
CL:
    buffer_load_dwordx4 v[30:33], v17, s[4:7], s24 offen offset:1024 sc1
    buffer_load_dwordx4 v[34:37], v0, s[4:7], s27 offen offset:0 sc1
    buffer_load_dwordx4 v[38:41], v0, s[4:7], s27 offen offset:2048 sc1
    buffer_load_dwordx4 v[42:45], v0, s[4:7], s28 offen offset:0 sc1
    buffer_load_dwordx4 v[46:49], v0, s[4:7], s28 offen offset:2048 sc1
CW:
    v_mov_b32 v62, 0x0c0c0706
    v_mov_b32 v63, 0x07060c0c
    v_mov_b32 v54, 0x44444444
    v_mov_b32 v56, 0xeeeeeeee
    v_cndmask_b32 v62, v62, v63, s[54:55]
    v_mov_b32 v60, 0x0c0c0c0c
    v_mov_b32 v61, 0x0c0c0c0c
    v_mov_b32_dpp v54, v56 quad_perm:[0,1,2,3] row_mask:0xf bank_mask:0xa
    v_mov_b32_dpp v60, v62 quad_perm:[0,1,2,3] row_mask:0xf bank_mask:0x3
    v_mov_b32_dpp v61, v62 quad_perm:[0,1,2,3] row_mask:0xf bank_mask:0xc

    v_max3_f32 v50, v26, v27, v28
    v_max_f32 v50, v50, v29
    s_nop 1
    v_max_f32_dpp v50, v50, v50 quad_perm:[2,3,0,1] row_mask:0xf bank_mask:0xf
    s_nop 1
    v_max_f32_dpp v50, v50, v50 row_bcast:15 row_mask:0xa bank_mask:0xf
    s_nop 1
    v_max_f32_dpp v50, v50, v50 row_bcast:31 row_mask:0xc bank_mask:0xf
    s_nop 0
    v_readlane_b32 s58, v50, 63
    s_nop 1
    v_subrev_f32 v26, s58, v26
    v_subrev_f32 v27, s58, v27
    v_subrev_f32 v28, s58, v28
    v_subrev_f32 v29, s58, v29
    v_exp_f32 v26, v26
    v_exp_f32 v27, v27
    v_exp_f32 v28, v28
    v_exp_f32 v29, v29
    v_perm_b32 v50, v26, v26, v60
    v_perm_b32 v51, v26, v26, v61
    v_perm_b32 v52, v27, v27, v60
    v_perm_b32 v53, v27, v27, v61
    v_perm_b32 v56, v28, v28, v60
    v_perm_b32 v57, v28, v28, v61
    v_perm_b32 v58, v29, v29, v60
    v_perm_b32 v59, v29, v29, v61
    v_and_b32 v26, 0xffff0000, v26
    v_and_b32 v27, 0xffff0000, v27
    v_and_b32 v28, 0xffff0000, v28
    v_and_b32 v29, 0xffff0000, v29
CO2:
    v_mov_b32 v60, 0
    v_mov_b32 v61, 0
    v_mov_b32 v62, 0
    v_mov_b32 v63, 0
    s_waitcnt vmcnt(4)
    v_mul_f32 v30, v26, v30
    v_fmac_f32 v30, v27, v31
    v_fmac_f32 v30, v28, v32
    v_fmac_f32 v30, v29, v33
    s_waitcnt vmcnt(2)
    v_smfmac_f32_16x16x64_bf16 v[60:63], v[50:53], v[34:41], v54

    v_add_f32_dpp v30, v30, v30 quad_perm:[2,3,0,1] row_mask:0xf bank_mask:0xf
    s_nop 1
    v_add_f32_dpp v30, v30, v30 row_bcast:15 row_mask:0xa bank_mask:0xf
    s_nop 1
    v_add_f32_dpp v30, v30, v30 row_bcast:31 row_mask:0xc bank_mask:0xf
    s_waitcnt vmcnt(0)
    v_smfmac_f32_16x16x64_bf16 v[60:63], v[56:59], v[42:49], v54
    v_readlane_b32 s59, v30, 63
    s_nop 1
    v_rcp_f32 v30, s59
    ds_read_b32 v43, v3
    s_nop 2
    v_add_f32_dpp v32, v62, v60 row_ror:8 row_mask:0xf bank_mask:0x3
    v_add_f32_dpp v33, v63, v61 row_ror:8 row_mask:0xf bank_mask:0x3
    s_nop 0
    v_add_f32_dpp v32, v60, v62 row_ror:8 row_mask:0xf bank_mask:0xc
    v_add_f32_dpp v33, v61, v63 row_ror:8 row_mask:0xf bank_mask:0xc
    v_pk_mul_f32 v[32:33], v[32:33], v[30:31] op_sel_hi:[1,0]
    v_cvt_pk_bf16_f32 v31, v32, v33
    ds_write_b32 v3, v31 offset:1024
    v_cmp_u_f32 vcc, v32, v33
    s_cbranch_vccnz RC_62

    ds_write_b32 v20, v21
    ds_read_b128 v[56:59], v19 offset:0
    ds_read_b128 v[26:29], v4 offset:1024
    ds_read_b128 v[30:33], v4 offset:1152
    ds_read_b128 v[34:37], v4 offset:1280
    ds_read_b128 v[38:41], v4 offset:1408
    v_mov_b32 v44, 0
    v_mov_b32 v45, 0
    v_mov_b32 v46, 0
    v_mov_b32 v47, 0
    v_mov_b32 v48, 0
    v_mov_b32 v49, 0
    v_mov_b32 v50, 0
    v_mov_b32 v51, 0
    s_cmp_lt_u32 s2, 6
    s_cbranch_scc1 LC_65
LB_66:
SC_64:
    s_waitcnt lgkmcnt(4)
    v_min3_u32 v56, v56, v57, v58
    v_min_u32 v56, v56, v59
    v_cmp_gt_u32 vcc, v21, v56
    s_cbranch_vccnz SY_63
    v_add_u32 v21, 1, v21
    s_cmp_lt_u32 s34, 2
    s_cbranch_scc1 AFTERX
    buffer_store_dword v43, v2, s[4:7], s18 offen sc1
AFTERX:
    s_waitcnt lgkmcnt(3)
    v_smfmac_f32_16x16x64_bf16 v[44:47], v[26:29], a[128:135], v5
    v_smfmac_f32_16x16x64_bf16 v[48:51], v[26:29], a[136:143], v5
    s_waitcnt lgkmcnt(2)
    v_smfmac_f32_16x16x64_bf16 v[44:47], v[30:33], a[144:151], v5
    v_smfmac_f32_16x16x64_bf16 v[48:51], v[30:33], a[152:159], v5
    s_waitcnt lgkmcnt(1)
    v_smfmac_f32_16x16x64_bf16 v[44:47], v[34:37], a[160:167], v5
    v_smfmac_f32_16x16x64_bf16 v[48:51], v[34:37], a[168:175], v5
    s_waitcnt lgkmcnt(0)
    v_smfmac_f32_16x16x64_bf16 v[44:47], v[38:41], a[176:183], v5
    v_smfmac_f32_16x16x64_bf16 v[48:51], v[38:41], a[184:191], v5
S3T:
    s_nop 6
    v_add_f32 v44, v44, v45
    v_add_f32 v48, v48, v49
    v_cvt_pk_bf16_f32 v44, v44, v48
    s_mov_b64 exec, s[42:43]
    buffer_store_dword v44, v18, s[4:7], s29 offen sc1
    s_mov_b64 exec, s[40:41]

NEXTU:
    s_cmp_lg_u32 s33, 0
    s_cbranch_scc1 LAST
    s_add_u32 s16, s16, 0x40000
    s_add_u32 s17, s17, 0x40000
    s_add_u32 s18, s18, 0x40000
    s_add_u32 s29, s29, 0x40000
    s_add_u32 s19, s19, 98304
    s_add_u32 s20, s20, 98304
    s_add_u32 s21, s21, 98304
    s_add_u32 s22, s22, 98304
    s_add_u32 s23, s23, 98304
    s_add_u32 s24, s24, 98304
    s_add_u32 s25, s25, 98304
    s_add_u32 s26, s26, 98304
    s_add_u32 s27, s27, 98304
    s_add_u32 s28, s28, 98304
    s_mov_b32 s33, 1
    s_lshl_b32 s34, s34, 1
    s_cmp_lg_u32 s35, 0
    s_cbranch_scc1 PROBE
    s_branch BFIRST
    .p2align 6
PAD_LAST:
    s_branch PADRET
LAST:
    s_cmp_eq_u32 s34, 0
    s_cbranch_scc1 EXIT
    s_cmp_lg_u32 s35, 0
    s_cbranch_scc1 EXIT
    s_add_u32 s16, s16, 262144
    s_add_u32 s17, s17, 262144
    s_mov_b32 s33, 2
    v_and_b32 v49, 63, v1
    v_lshrrev_b32 v49, 1, v49
    v_and_b32 v48, 64, v1
    v_add_u32 v49, v49, v48

    s_cmp_lg_u32 s39, 0
    s_cbranch_scc1 FL1
    v_mov_b32 v26, s62
    s_mov_b64 exec, 1
    buffer_store_dword v26, off, s[4:7], 0 sc1
    s_mov_b64 exec, -1

FL1:
    buffer_load_dwordx4 v[52:55], v0, s[4:7], s16 offen sc1
    buffer_load_dwordx4 v[56:59], v0, s[4:7], s16 offen offset:2048 sc1
    buffer_load_dword v42, v1, s[4:7], s17 offen sc1

    buffer_load_dwordx4 v[52:55], v0, s[4:7], s16 offen sc1
    buffer_load_dwordx4 v[56:59], v0, s[4:7], s16 offen offset:2048 sc1
    buffer_load_dword v42, v1, s[4:7], s17 offen sc1

    v_mov_b32 v44, s36
    v_mov_b32 v45, s37
    v_mov_b32 v46, 0x44444444
    v_mov_b32 v47, 0xeeeeeeee
    v_cndmask_b32 v44, v44, v45, s[54:55]
    v_mov_b32 v38, 0
    v_mov_b32 v39, 0
    v_mov_b32_dpp v46, v47 quad_perm:[0,1,2,3] row_mask:0xf bank_mask:0xa
    v_mov_b32_dpp v38, v44 quad_perm:[0,1,2,3] row_mask:0xf bank_mask:0x3
    v_mov_b32_dpp v39, v44 quad_perm:[0,1,2,3] row_mask:0xf bank_mask:0xc
    v_mov_b32 v34, 0
    v_mov_b32 v35, 0
    v_mov_b32 v40, v38
    v_mov_b32 v41, v39

FW:
    s_waitcnt vmcnt(5)
    v_max3_u32 v44, v52, v53, v54
    s_waitcnt vmcnt(4)
    v_max3_u32 v45, v56, v57, v58
    v_max3_u32 v44, v44, v55, v59
    v_smfmac_f32_16x16x64_bf16 v[34:37], v[38:41], v[52:59], v46
    s_waitcnt vmcnt(3)
    v_max3_u32 v44, v44, v45, v42
    v_and_b32 v45, 0xffff0000, v42
    v_cmp_eq_u32 vcc, -1, v44
    v_lshlrev_b32 v44, 16, v42
    s_cbranch_vccnz FR

FU:
    s_nop 1
    v_add_f32_dpp v34, v34, v34 row_ror:8 row_mask:0xf bank_mask:0xf
    v_add_f32_dpp v35, v35, v35 row_ror:8 row_mask:0xf bank_mask:0xf
    v_pk_add_f32 v[34:35], v[34:35], v[44:45]
    v_cvt_pk_bf16_f32 v43, v34, v35
    buffer_store_short v43, v49, s[12:15], s39 offen
    buffer_store_short_d16_hi v43, v49, s[12:15], s39 offen offset:32

    s_endpgm
FR:
    buffer_load_dwordx4 v[52:55], v0, s[4:7], s16 offen sc1
    buffer_load_dwordx4 v[56:59], v0, s[4:7], s16 offen offset:2048 sc1
    buffer_load_dword v42, v1, s[4:7], s17 offen sc1

    s_sub_u32 s32, s32, 1
    v_mov_b32 v34, 0
    v_mov_b32 v35, 0
    s_cbranch_scc0 FW
    s_branch FAIL
FR2:
    s_waitcnt vmcnt(0)
    s_sub_u32 s32, s32, 1
    s_cbranch_scc0 FL1
    s_branch FAIL
FIN2:
    s_endpgm
LD:
    ds_read_b128 v[60:63], v19 offset:16
    s_cmp_eq_u32 s2, 5
    s_cbranch_scc1 LP5
    s_cmp_eq_u32 s2, 4
    s_cbranch_scc1 LP4
    s_cmp_eq_u32 s2, 3
    s_cbranch_scc1 LP3
    s_cmp_eq_u32 s2, 2
    s_cbranch_scc1 LP2
    s_cmp_eq_u32 s2, 1
    s_cbranch_scc1 LP1
LP0:
    s_waitcnt lgkmcnt(0)
    v_min3_i32 v60, v60, v61, v62
    v_min_i32 v60, v60, v63
LQ0:
    v_cmp_gt_i32 vcc, 24, v60
    s_cbranch_vccnz LDW
    v_mbcnt_lo_u32_b32 v61, -1, 0
    v_mbcnt_hi_u32_b32 v61, -1, v61
    v_and_b32 v62, 15, v61
    v_lshrrev_b32 v61, 4, v61
    v_xor_b32 v61, v61, v62
    v_lshlrev_b32 v61, 4, v61
    v_lshl_add_u32 v52, v62, 8, v61
    s_lshl_b32 s58, s3, 13
    s_add_u32 s58, s58, 73728
    v_add_u32 v52, s58, v52
    v_xor_b32 v53, 64, v52
    v_xor_b32 v61, 0x80, v52
    v_xor_b32 v62, 0xc0, v52

    ds_read_b128 a[64:67], v52 offset:0
    ds_read_b128 a[68:71], v53 offset:0
    ds_read_b128 a[72:75], v61 offset:0
    ds_read_b128 a[76:79], v62 offset:0
    ds_read_b128 a[80:83], v52 offset:4096
    ds_read_b128 a[84:87], v53 offset:4096
    ds_read_b128 a[88:91], v61 offset:4096
    ds_read_b128 a[92:95], v62 offset:4096
    s_mov_b32 s2, 1
    s_cmp_eq_u32 s101, 1
    s_cbranch_scc1 LDR
    s_branch LQ1
LP1:
    s_waitcnt lgkmcnt(0)
    v_min3_i32 v60, v60, v61, v62
    v_min_i32 v60, v60, v63
LQ1:
    v_cmp_gt_i32 vcc, 32, v60
    s_cbranch_vccnz LDW
    v_add_u32 v52, 98304, v55
    v_xor_b32 v53, 32, v52
    ds_read_b64_tr_b16 a[96:97], v52 offset:0
    ds_read_b64_tr_b16 a[98:99], v52 offset:512
    ds_read_b64_tr_b16 a[100:101], v52 offset:8192
    ds_read_b64_tr_b16 a[102:103], v52 offset:8704
    ds_read_b64_tr_b16 a[104:105], v53 offset:0
    ds_read_b64_tr_b16 a[106:107], v53 offset:512
    ds_read_b64_tr_b16 a[108:109], v53 offset:8192
    ds_read_b64_tr_b16 a[110:111], v53 offset:8704
    ds_read_b64_tr_b16 a[112:113], v52 offset:16384
    ds_read_b64_tr_b16 a[114:115], v52 offset:16896
    ds_read_b64_tr_b16 a[116:117], v52 offset:24576
    ds_read_b64_tr_b16 a[118:119], v52 offset:25088
    ds_read_b64_tr_b16 a[120:121], v53 offset:16384
    ds_read_b64_tr_b16 a[122:123], v53 offset:16896
    ds_read_b64_tr_b16 a[124:125], v53 offset:24576
    ds_read_b64_tr_b16 a[126:127], v53 offset:25088
    s_mov_b32 s2, 2
    s_cmp_eq_u32 s101, 2
    s_cbranch_scc1 LDR
    s_branch LQ2
LP2:
    s_waitcnt lgkmcnt(0)
    v_min3_i32 v60, v60, v61, v62
    v_min_i32 v60, v60, v63
LQ2:
    v_cmp_gt_i32 vcc, 36, v60
    s_cbranch_vccnz LDW
    v_mov_b32 v52, v55
    v_xor_b32 v53, 32, v55
    ds_read_b64_tr_b16 a[128:129], v52 offset:0
    ds_read_b64_tr_b16 a[130:131], v52 offset:512
    ds_read_b64_tr_b16 a[132:133], v52 offset:8192
    ds_read_b64_tr_b16 a[134:135], v52 offset:8704
    ds_read_b64_tr_b16 a[136:137], v53 offset:0
    ds_read_b64_tr_b16 a[138:139], v53 offset:512
    ds_read_b64_tr_b16 a[140:141], v53 offset:8192
    ds_read_b64_tr_b16 a[142:143], v53 offset:8704
    s_mov_b32 s2, 3
    s_branch LQ3
LP3:
    s_waitcnt lgkmcnt(0)
    v_min3_i32 v60, v60, v61, v62
    v_min_i32 v60, v60, v63
LQ3:
    v_cmp_gt_i32 vcc, 40, v60
    s_cbranch_vccnz LDW
    v_mov_b32 v52, v55
    v_xor_b32 v53, 32, v55
    ds_read_b64_tr_b16 a[144:145], v52 offset:16384
    ds_read_b64_tr_b16 a[146:147], v52 offset:16896
    ds_read_b64_tr_b16 a[148:149], v52 offset:24576
    ds_read_b64_tr_b16 a[150:151], v52 offset:25088
    ds_read_b64_tr_b16 a[152:153], v53 offset:16384
    ds_read_b64_tr_b16 a[154:155], v53 offset:16896
    ds_read_b64_tr_b16 a[156:157], v53 offset:24576
    ds_read_b64_tr_b16 a[158:159], v53 offset:25088
    s_mov_b32 s2, 4
    s_branch LQ4
LP4:
    s_waitcnt lgkmcnt(0)
    v_min3_i32 v60, v60, v61, v62
    v_min_i32 v60, v60, v63
LQ4:
    v_cmp_gt_i32 vcc, 44, v60
    s_cbranch_vccnz LDW
    v_mov_b32 v52, v55
    v_xor_b32 v53, 32, v55
    ds_read_b64_tr_b16 a[160:161], v52 offset:32768
    ds_read_b64_tr_b16 a[162:163], v52 offset:33280
    ds_read_b64_tr_b16 a[164:165], v52 offset:40960
    ds_read_b64_tr_b16 a[166:167], v52 offset:41472
    ds_read_b64_tr_b16 a[168:169], v53 offset:32768
    ds_read_b64_tr_b16 a[170:171], v53 offset:33280
    ds_read_b64_tr_b16 a[172:173], v53 offset:40960
    ds_read_b64_tr_b16 a[174:175], v53 offset:41472
    s_mov_b32 s2, 5
    s_branch LQ5
LP5:
    s_waitcnt lgkmcnt(0)
    v_min3_i32 v60, v60, v61, v62
    v_min_i32 v60, v60, v63
LQ5:
    v_cmp_gt_i32 vcc, 48, v60
    s_cbranch_vccnz LDW
    v_mov_b32 v52, v55
    v_xor_b32 v53, 32, v55
    ds_read_b64_tr_b16 a[176:177], v52 offset:49152
    ds_read_b64_tr_b16 a[178:179], v52 offset:49664
    ds_read_b64_tr_b16 a[180:181], v52 offset:57344
    ds_read_b64_tr_b16 a[182:183], v52 offset:57856
    ds_read_b64_tr_b16 a[184:185], v53 offset:49152
    ds_read_b64_tr_b16 a[186:187], v53 offset:49664
    ds_read_b64_tr_b16 a[188:189], v53 offset:57344
    ds_read_b64_tr_b16 a[190:191], v53 offset:57856
    s_mov_b32 s2, 6
LDR:
    s_waitcnt lgkmcnt(0)
    s_setpc_b64 s[0:1]
LDW:
    s_cmp_ge_u32 s2, s101
    s_cbranch_scc1 LDR
    s_sub_u32 s32, s32, 1
    s_cbranch_scc0 LD
    s_branch FAIL
    .p2align 7
    s_nop 0
    s_nop 0
    s_nop 0
    s_nop 0
PAD_S0:
    s_branch PAD_SB
LOOP_S:
APOLL_S:
    buffer_load_dwordx4 v[52:55], v0, s[4:7], s16 offen sc1
    buffer_load_dwordx4 v[56:59], v0, s[4:7], s16 offen offset:2048 sc1
    buffer_load_dword v42, v1, s[4:7], s17 offen sc1

    buffer_load_dwordx4 v[52:55], v0, s[4:7], s16 offen sc1
    buffer_load_dwordx4 v[56:59], v0, s[4:7], s16 offen offset:2048 sc1
    buffer_load_dword v42, v1, s[4:7], s17 offen sc1

    v_mov_b32 v44, s36
    v_mov_b32 v45, s37
    v_mov_b32 v46, 0x44444444
    v_mov_b32 v47, 0xeeeeeeee
    v_cndmask_b32 v44, v44, v45, s[54:55]
    v_mov_b32 v38, 0
    v_mov_b32 v39, 0
    v_mov_b32_dpp v46, v47 quad_perm:[0,1,2,3] row_mask:0xf bank_mask:0xa
    v_mov_b32_dpp v38, v44 quad_perm:[0,1,2,3] row_mask:0xf bank_mask:0x3
    v_mov_b32_dpp v39, v44 quad_perm:[0,1,2,3] row_mask:0xf bank_mask:0xc
    v_mov_b32 v34, 0
    v_mov_b32 v35, 0
    v_mov_b32 v40, v38
    v_mov_b32 v41, v39

AW_S:
    s_waitcnt vmcnt(5)
    v_max3_u32 v44, v52, v53, v54
    s_waitcnt vmcnt(4)
    v_max3_u32 v45, v56, v57, v58
    v_max3_u32 v44, v44, v55, v59
    v_smfmac_f32_16x16x64_bf16 v[34:37], v[38:41], v[52:59], v46
    s_waitcnt vmcnt(3)
    v_max3_u32 v44, v44, v45, v42
    v_and_b32 v45, 0xffff0000, v42
    v_cmp_eq_u32 vcc, -1, v44
    v_lshlrev_b32 v44, 16, v42
    s_cbranch_vccnz AR_S

AU_S:
    s_nop 1
    v_add_f32_dpp v34, v34, v34 row_ror:8 row_mask:0xf bank_mask:0xf
    v_add_f32_dpp v35, v35, v35 row_ror:8 row_mask:0xf bank_mask:0xf
    v_pk_add_f32 v[34:35], v[34:35], v[44:45]
    v_cvt_pk_bf16_f32 v43, v34, v35
    ds_write_b32 v3, v43

    v_dot2_f32_bf16 v46, v43, s38, 0
    v_dot2_f32_bf16 v47, v43, v43, 0
    v_mov_b32 v44, 0
    v_mov_b32 v45, 0
    v_add_f32_dpp v46, v46, v46 quad_perm:[1,0,3,2] row_mask:0xf bank_mask:0xf
    v_add_f32_dpp v47, v47, v47 quad_perm:[1,0,3,2] row_mask:0xf bank_mask:0xf
    v_mov_b32 v48, 0
    v_mov_b32 v49, 0
    v_add_f32_dpp v46, v46, v46 quad_perm:[2,3,0,1] row_mask:0xf bank_mask:0xf
    v_add_f32_dpp v47, v47, v47 quad_perm:[2,3,0,1] row_mask:0xf bank_mask:0xf
    s_mov_b64 exec, s[50:51]
    buffer_store_dwordx2 v[46:47], off, s[4:7], s20
    s_mov_b64 exec, s[40:41]
    s_waitcnt lgkmcnt(0)
    s_barrier
    ds_read_b128 v[26:29], v4 offset:0
    ds_read_b128 v[30:33], v4 offset:128
    ds_read_b128 v[34:37], v4 offset:256
    ds_read_b128 v[38:41], v4 offset:384
S1GO_S:
    s_waitcnt lgkmcnt(3)
    v_smfmac_f32_16x16x64_bf16 v[44:47], v[26:29], a[0:7], v5
    v_smfmac_f32_16x16x64_bf16 v[48:51], v[26:29], a[8:15], v5
    s_waitcnt lgkmcnt(2)
    v_smfmac_f32_16x16x64_bf16 v[44:47], v[30:33], a[16:23], v5
    v_smfmac_f32_16x16x64_bf16 v[48:51], v[30:33], a[24:31], v5
    s_waitcnt lgkmcnt(1)
    v_smfmac_f32_16x16x64_bf16 v[44:47], v[34:37], a[32:39], v5
    v_smfmac_f32_16x16x64_bf16 v[48:51], v[34:37], a[40:47], v5
    s_waitcnt lgkmcnt(0)
    v_smfmac_f32_16x16x64_bf16 v[44:47], v[38:41], a[48:55], v5
    v_smfmac_f32_16x16x64_bf16 v[48:51], v[38:41], a[56:63], v5
    s_nop 6
    v_add_f32 v44, v44, v45
    v_add_f32 v48, v48, v49
    v_cndmask_b32 v44, v44, v48, s[52:53]
    s_mov_b64 exec, s[44:45]

    buffer_store_dword v44, v6, s[4:7], s19 offen
    s_mov_b64 exec, s[40:41]
BST_S:
    buffer_load_dwordx4 v[56:59], v7, s[4:7], s21 offen sc1
    s_branch PADX_SB
PAD_SB:
    s_branch PAD_SC
PADX_SB:
    v_mov_b32 v44, 0
    v_mov_b32 v45, 0
    v_mov_b32 v46, 0
    v_mov_b32 v47, 0
    v_mov_b32 v48, 0
    v_mov_b32 v49, 0
    v_mov_b32 v50, 0
    v_mov_b32 v51, 0
    s_waitcnt vmcnt(0)
    v_pk_add_f32 v[26:27], v[56:57], v[58:59]

    v_cmp_u_f32 vcc, v26, v27
    s_cbranch_vccnz RT_67

    buffer_load_dwordx4 v[28:31], v8, s[4:7], s22 offen offset:0 sc1
    buffer_load_dwordx4 v[32:35], v8, s[4:7], s22 offen offset:512 sc1
    buffer_load_dwordx4 v[36:39], v8, s[4:7], s22 offen offset:1024 sc1
    buffer_load_dwordx4 v[40:43], v8, s[4:7], s22 offen offset:1536 sc1
BS_S:
    v_add_f32_dpp v26, v26, v26 row_ror:8 row_mask:0xf bank_mask:0xf
    v_add_f32_dpp v27, v27, v27 row_ror:8 row_mask:0xf bank_mask:0xf
    s_nop 0
    v_add_f32_dpp v26, v26, v26 row_ror:4 row_mask:0xf bank_mask:0xf
    v_add_f32_dpp v27, v27, v27 row_ror:4 row_mask:0xf bank_mask:0xf
    s_nop 0
    v_add_f32_dpp v26, v26, v26 row_ror:2 row_mask:0xf bank_mask:0xf
    v_add_f32_dpp v27, v27, v27 row_ror:2 row_mask:0xf bank_mask:0xf
    s_nop 0
    v_add_f32_dpp v26, v26, v26 row_ror:1 row_mask:0xf bank_mask:0xf
    v_add_f32_dpp v27, v27, v27 row_ror:1 row_mask:0xf bank_mask:0xf
    s_nop 0
    v_add_f32_dpp v26, v26, v26 row_bcast:15 row_mask:0xa bank_mask:0xf
    v_add_f32_dpp v27, v27, v27 row_bcast:15 row_mask:0xa bank_mask:0xf
    s_nop 0
    v_add_f32_dpp v26, v26, v26 row_bcast:31 row_mask:0xc bank_mask:0xf
    v_add_f32_dpp v27, v27, v27 row_bcast:31 row_mask:0xc bank_mask:0xf
    v_mul_f32 v26, 0xba800000, v26
    v_mov_b32 v54, 0x3727c5ac
    v_fmac_f32 v54, 0x3a800000, v27
    v_fma_f32 v54, -v26, v26, v54
    v_rsq_f32 v54, v54
    s_nop 0
    v_mul_f32 v54, 0x3e0293ee, v54

    v_mul_f32 v26, v26, v54
    s_nop 0
    v_readlane_b32 s58, v26, 63
    v_readlane_b32 s59, v54, 63
BQ1_S:
    s_nop 1
    v_pk_mul_f32 v[62:63], v[24:25], s[58:59] op_sel_hi:[1,0]
    v_pk_mul_f32 v[60:61], v[22:23], s[58:59] op_sel_hi:[1,0]

BQ2_S:
    s_waitcnt vmcnt(3)
    v_pk_fma_f32 v[28:29], v[28:29], s[58:59], v[60:61] op_sel:[0,1,0] op_sel_hi:[1,1,1]
    v_pk_fma_f32 v[30:31], v[30:31], s[58:59], v[62:63] op_sel:[0,1,0] op_sel_hi:[1,1,1]
    s_waitcnt vmcnt(2)
    v_pk_fma_f32 v[28:29], v[32:33], s[58:59], v[28:29] op_sel:[0,1,0] op_sel_hi:[1,1,1]
    v_pk_fma_f32 v[30:31], v[34:35], s[58:59], v[30:31] op_sel:[0,1,0] op_sel_hi:[1,1,1]
    s_waitcnt vmcnt(1)
    v_pk_fma_f32 v[28:29], v[36:37], s[58:59], v[28:29] op_sel:[0,1,0] op_sel_hi:[1,1,1]
    v_pk_fma_f32 v[30:31], v[38:39], s[58:59], v[30:31] op_sel:[0,1,0] op_sel_hi:[1,1,1]
    s_waitcnt vmcnt(0)
    v_pk_fma_f32 v[28:29], v[40:41], s[58:59], v[28:29] op_sel:[0,1,0] op_sel_hi:[1,1,1]
    v_pk_fma_f32 v[30:31], v[42:43], s[58:59], v[30:31] op_sel:[0,1,0] op_sel_hi:[1,1,1]
    v_cvt_pk_bf16_f32 v32, v28, v29
    v_cvt_pk_bf16_f32 v33, v30, v31
    ds_write2_b32 v9, v32, v33 offset1:4
    v_cmp_u_f32 vcc, v28, v29
    v_cmp_u_f32 s[56:57], v30, v31

    s_or_b64 vcc, vcc, s[56:57]
    s_cbranch_vccnz RB_68

    s_waitcnt lgkmcnt(0)
    s_barrier
    ds_read_b128 v[26:29], v10 offset:0
    ds_read_b128 v[30:33], v10 offset:1152
    s_waitcnt lgkmcnt(1)
    v_smfmac_f32_16x16x64_bf16 v[44:47], v[26:29], a[64:71], v5
    v_smfmac_f32_16x16x64_bf16 v[48:51], v[26:29], a[80:87], v5
    s_waitcnt lgkmcnt(0)
    v_smfmac_f32_16x16x64_bf16 v[44:47], v[30:33], a[72:79], v5
    v_smfmac_f32_16x16x64_bf16 v[48:51], v[30:33], a[88:95], v5
    s_nop 6
    v_add_f32 v34, v44, v45
    v_add_f32 v36, v46, v47
    v_add_f32 v35, v48, v49
    v_add_f32 v37, v50, v51
    v_max_f32 v38, v34, v35
    v_max_f32 v39, v36, v37

    s_nop 0
    v_max_f32_dpp v40, v38, v38 row_ror:8 row_mask:0xf bank_mask:0x3
    s_nop 1
    v_max_f32_dpp v40, v39, v39 row_ror:8 row_mask:0xf bank_mask:0xc
    s_nop 1
    v_max_f32_dpp v40, v40, v40 row_half_mirror row_mask:0xf bank_mask:0xf
    s_nop 1
    v_max_f32_dpp v40, v40, v40 quad_perm:[1,0,3,2] row_mask:0xf bank_mask:0xf
    s_nop 1
    v_max_f32_dpp v40, v40, v40 quad_perm:[2,3,0,1] row_mask:0xf bank_mask:0xf
    ds_write_b32 v11, v40
    s_waitcnt lgkmcnt(0)
    s_barrier
    ds_read_b128 v[26:29], v12 offset:0
    ds_read_b128 v[30:33], v12 offset:16
    v_mov_b32 v44, 0
    v_mov_b32 v45, 0
    v_mov_b32 v46, 0
    v_mov_b32 v47, 0
    v_mov_b32 v48, 0
    v_mov_b32 v49, 0
    v_mov_b32 v50, 0
    v_mov_b32 v51, 0
    s_waitcnt lgkmcnt(1)
    v_max3_f32 v26, v26, v27, v28
    v_max_f32 v26, v26, v29
    s_waitcnt lgkmcnt(0)
    v_max3_f32 v30, v30, v31, v32
    v_max_f32 v30, v30, v33

    v_pk_add_f32 v[34:35], v[34:35], v[26:27] op_sel_hi:[1,0] neg_lo:[0,1] neg_hi:[0,1]
    v_pk_add_f32 v[36:37], v[36:37], v[30:31] op_sel_hi:[1,0] neg_lo:[0,1] neg_hi:[0,1]
    v_exp_f32 v34, v34
    v_exp_f32 v35, v35
    v_exp_f32 v36, v36
    v_exp_f32 v37, v37
    v_cvt_pk_bf16_f32 v38, v34, v35
    v_cvt_pk_bf16_f32 v39, v36, v37
    ds_write2_b32 v13, v38, v39 offset1:8

    s_waitcnt lgkmcnt(0)
    s_barrier
    ds_read_b128 v[32:35], v10 offset:2304
    ds_read_b128 v[36:39], v10 offset:3456
    s_cmp_lg_u32 s3, 0
    s_cbranch_scc1 NM_69
    v_cndmask_b32 v40, v26, v30, s[54:55]
    s_mov_b64 exec, s[46:47]
    buffer_store_dword v40, v14, s[4:7], s23 offen
    s_mov_b64 exec, s[40:41]
NM_69:
    s_waitcnt lgkmcnt(1)
    v_smfmac_f32_16x16x64_bf16 v[44:47], v[32:35], a[96:103], v5
    v_smfmac_f32_16x16x64_bf16 v[48:51], v[32:35], a[104:111], v5
    s_waitcnt lgkmcnt(0)
    v_smfmac_f32_16x16x64_bf16 v[44:47], v[36:39], a[112:119], v5
    v_smfmac_f32_16x16x64_bf16 v[48:51], v[36:39], a[120:127], v5
    s_cmp_lg_u32 s3, 1
    s_cbranch_scc1 NOL_S
    v_dot2_f32_bf16 v40, v32, s38, 0
    v_dot2_f32_bf16 v40, v33, s38, v40
    v_dot2_f32_bf16 v40, v34, s38, v40
    v_dot2_f32_bf16 v40, v35, s38, v40
    v_dot2_f32_bf16 v40, v36, s38, v40
    v_dot2_f32_bf16 v40, v37, s38, v40
    v_dot2_f32_bf16 v40, v38, s38, v40
    v_dot2_f32_bf16 v40, v39, s38, v40
    s_nop 2
    v_add_f32_dpp v40, v40, v40 quad_perm:[1,0,3,2] row_mask:0xf bank_mask:0xf
    v_mov_b32 v41, v40
    s_nop 1
    v_permlane16_swap_b32 v40, v41
    v_add_f32 v40, v40, v41
    v_mov_b32 v41, v40
    s_nop 1
    v_permlane32_swap_b32 v40, v41
    v_add_f32 v40, v40, v41

    s_mov_b64 exec, s[48:49]
    buffer_store_dword v40, v15, s[4:7], s23 offen offset:1024
    s_mov_b64 exec, s[40:41]
NOL_S:
    s_nop 4
    v_add_f32 v44, v44, v45
    v_add_f32 v46, v46, v47
    v_add_f32 v48, v48, v49
    v_add_f32 v50, v50, v51
    v_cvt_pk_bf16_f32 v44, v44, v48
    v_cvt_pk_bf16_f32 v46, v46, v50

    buffer_store_dword v44, v16, s[4:7], s25 offen
    buffer_store_dword v46, v16, s[4:7], s26 offen
CM_S:
    buffer_load_dwordx4 v[26:29], v17, s[4:7], s24 offen sc1
    s_branch PADX_SC
PAD_SC:
    s_branch PAD_SO
PADX_SC:
    v_mov_b32 v62, 0x0c0c0706
    v_mov_b32 v63, 0x07060c0c
    v_mov_b32 v54, 0x44444444
    v_mov_b32 v56, 0xeeeeeeee
    v_cndmask_b32 v62, v62, v63, s[54:55]
    v_mov_b32 v60, 0x0c0c0c0c
    v_mov_b32 v61, 0x0c0c0c0c
    v_mov_b32_dpp v54, v56 quad_perm:[0,1,2,3] row_mask:0xf bank_mask:0xa
    v_mov_b32_dpp v60, v62 quad_perm:[0,1,2,3] row_mask:0xf bank_mask:0x3
    v_mov_b32_dpp v61, v62 quad_perm:[0,1,2,3] row_mask:0xf bank_mask:0xc

    s_waitcnt vmcnt(0)
    v_pk_add_f32 v[50:51], v[26:27], v[28:29]
    v_cmp_u_f32 vcc, v50, v51
    s_cbranch_vccnz RT_70
CL_S:
    buffer_load_dwordx4 v[30:33], v17, s[4:7], s24 offen offset:1024 sc1
    buffer_load_dwordx4 v[34:37], v0, s[4:7], s27 offen offset:0 sc1
    buffer_load_dwordx4 v[38:41], v0, s[4:7], s27 offen offset:2048 sc1
    buffer_load_dwordx4 v[42:45], v0, s[4:7], s28 offen offset:0 sc1
    buffer_load_dwordx4 v[46:49], v0, s[4:7], s28 offen offset:2048 sc1
CW_S:
    v_max3_f32 v50, v26, v27, v28
    v_max_f32 v50, v50, v29
    s_nop 1
    v_max_f32_dpp v50, v50, v50 quad_perm:[2,3,0,1] row_mask:0xf bank_mask:0xf
    s_nop 1
    v_max_f32_dpp v50, v50, v50 row_bcast:15 row_mask:0xa bank_mask:0xf
    s_nop 1
    v_max_f32_dpp v50, v50, v50 row_bcast:31 row_mask:0xc bank_mask:0xf
    s_nop 0
    v_readlane_b32 s58, v50, 63
    s_nop 1
    v_subrev_f32 v26, s58, v26
    v_subrev_f32 v27, s58, v27
    v_subrev_f32 v28, s58, v28
    v_subrev_f32 v29, s58, v29
    v_exp_f32 v26, v26
    v_exp_f32 v27, v27
    v_exp_f32 v28, v28
    v_exp_f32 v29, v29
    v_perm_b32 v50, v26, v26, v60
    v_perm_b32 v51, v26, v26, v61
    v_perm_b32 v52, v27, v27, v60
    v_perm_b32 v53, v27, v27, v61
    v_perm_b32 v56, v28, v28, v60
    v_perm_b32 v57, v28, v28, v61
    v_perm_b32 v58, v29, v29, v60
    v_perm_b32 v59, v29, v29, v61
    v_and_b32 v26, 0xffff0000, v26
    v_and_b32 v27, 0xffff0000, v27
    v_and_b32 v28, 0xffff0000, v28
    v_and_b32 v29, 0xffff0000, v29
CO2_S:
    v_mov_b32 v60, 0
    v_mov_b32 v61, 0
    v_mov_b32 v62, 0
    v_mov_b32 v63, 0
    s_waitcnt vmcnt(4)
    v_mul_f32 v30, v26, v30
    v_fmac_f32 v30, v27, v31
    v_fmac_f32 v30, v28, v32
    v_fmac_f32 v30, v29, v33
    s_waitcnt vmcnt(2)
    v_smfmac_f32_16x16x64_bf16 v[60:63], v[50:53], v[34:41], v54

    v_add_f32_dpp v30, v30, v30 quad_perm:[2,3,0,1] row_mask:0xf bank_mask:0xf
    s_nop 1
    v_add_f32_dpp v30, v30, v30 row_bcast:15 row_mask:0xa bank_mask:0xf
    s_nop 1
    v_add_f32_dpp v30, v30, v30 row_bcast:31 row_mask:0xc bank_mask:0xf
    s_waitcnt vmcnt(0)
    v_smfmac_f32_16x16x64_bf16 v[60:63], v[56:59], v[42:49], v54
    v_readlane_b32 s59, v30, 63
    s_nop 1
    v_rcp_f32 v30, s59
    ds_read_b32 v43, v3
    s_nop 2
    v_add_f32_dpp v32, v62, v60 row_ror:8 row_mask:0xf bank_mask:0x3
    v_add_f32_dpp v33, v63, v61 row_ror:8 row_mask:0xf bank_mask:0x3
    s_nop 0
    v_add_f32_dpp v32, v60, v62 row_ror:8 row_mask:0xf bank_mask:0xc
    v_add_f32_dpp v33, v61, v63 row_ror:8 row_mask:0xf bank_mask:0xc
    v_pk_mul_f32 v[32:33], v[32:33], v[30:31] op_sel_hi:[1,0]
    v_cvt_pk_bf16_f32 v31, v32, v33
    ds_write_b32 v3, v31 offset:1024
    v_cmp_u_f32 vcc, v32, v33
    s_cbranch_vccnz RC_71

    v_mov_b32 v44, 0
    v_mov_b32 v45, 0
    v_mov_b32 v46, 0
    v_mov_b32 v47, 0
    v_mov_b32 v48, 0
    v_mov_b32 v49, 0
    v_mov_b32 v50, 0
    v_mov_b32 v51, 0
    s_waitcnt lgkmcnt(0)
    s_barrier
    ds_read_b128 v[26:29], v4 offset:1024
    ds_read_b128 v[30:33], v4 offset:1152
    ds_read_b128 v[34:37], v4 offset:1280
    ds_read_b128 v[38:41], v4 offset:1408
    s_cmp_lt_u32 s34, 2
    s_cbranch_scc1 AFTERX_S
    buffer_store_dword v43, v2, s[4:7], s18 offen sc1
AFTERX_S:
    s_waitcnt lgkmcnt(3)
    v_smfmac_f32_16x16x64_bf16 v[44:47], v[26:29], a[128:135], v5
    v_smfmac_f32_16x16x64_bf16 v[48:51], v[26:29], a[136:143], v5
    s_waitcnt lgkmcnt(2)
    v_smfmac_f32_16x16x64_bf16 v[44:47], v[30:33], a[144:151], v5
    v_smfmac_f32_16x16x64_bf16 v[48:51], v[30:33], a[152:159], v5
    s_waitcnt lgkmcnt(1)
    v_smfmac_f32_16x16x64_bf16 v[44:47], v[34:37], a[160:167], v5
    v_smfmac_f32_16x16x64_bf16 v[48:51], v[34:37], a[168:175], v5
    s_waitcnt lgkmcnt(0)
    v_smfmac_f32_16x16x64_bf16 v[44:47], v[38:41], a[176:183], v5
    v_smfmac_f32_16x16x64_bf16 v[48:51], v[38:41], a[184:191], v5
S3T_S:
    s_nop 6
    v_add_f32 v44, v44, v45
    v_add_f32 v48, v48, v49
    v_cvt_pk_bf16_f32 v44, v44, v48
    s_mov_b64 exec, s[42:43]
    buffer_store_dword v44, v18, s[4:7], s29 offen sc1
    s_mov_b64 exec, s[40:41]

    s_cmp_eq_u32 s33, 0
    s_cbranch_scc1 NEXTU
    s_branch LAST
PAD_SO:
    s_branch SPADRET
AR_S:
    buffer_load_dwordx4 v[52:55], v0, s[4:7], s16 offen sc1
    buffer_load_dwordx4 v[56:59], v0, s[4:7], s16 offen offset:2048 sc1
    buffer_load_dword v42, v1, s[4:7], s17 offen sc1

    s_sub_u32 s32, s32, 1
    v_mov_b32 v34, 0
    v_mov_b32 v35, 0
    s_cbranch_scc0 AW_S
    s_branch FAIL
RT_67:
    s_sub_u32 s32, s32, 1
    s_cbranch_scc0 BST_S
    s_branch FAIL
RB_68:
    buffer_load_dwordx4 v[28:31], v8, s[4:7], s22 offen offset:0 sc1
    buffer_load_dwordx4 v[32:35], v8, s[4:7], s22 offen offset:512 sc1
    buffer_load_dwordx4 v[36:39], v8, s[4:7], s22 offen offset:1024 sc1
    buffer_load_dwordx4 v[40:43], v8, s[4:7], s22 offen offset:1536 sc1
    s_sub_u32 s32, s32, 1
    s_cbranch_scc0 BQ2_S
    s_branch FAIL
RT_70:
    s_sub_u32 s32, s32, 1
    s_cbranch_scc0 CM_S
    s_branch FAIL
RC_71:
    s_waitcnt lgkmcnt(0)
    buffer_load_dwordx4 v[30:33], v17, s[4:7], s24 offen offset:1024 sc1
    buffer_load_dwordx4 v[34:37], v0, s[4:7], s27 offen offset:0 sc1
    buffer_load_dwordx4 v[38:41], v0, s[4:7], s27 offen offset:2048 sc1
    buffer_load_dwordx4 v[42:45], v0, s[4:7], s28 offen offset:0 sc1
    buffer_load_dwordx4 v[46:49], v0, s[4:7], s28 offen offset:2048 sc1
    s_sub_u32 s32, s32, 1
    s_cbranch_scc0 CO2_S
    s_branch FAIL
    .p2align 7
PAD_O0:
    s_branch PAD_O1
RT_3:
    s_sub_u32 s32, s32, 1
    s_cbranch_scc0 HS_2
    s_branch FAIL
RT_5:
    s_sub_u32 s32, s32, 1
    s_cbranch_scc0 WL_4
    s_branch FAIL
RT_7:
    s_sub_u32 s32, s32, 1
    s_cbranch_scc0 WL_6
    s_branch FAIL
RT_10:
    s_sub_u32 s32, s32, 1
    s_cbranch_scc0 WL_9
    s_branch FAIL
RT_13:
    s_sub_u32 s32, s32, 1
    s_cbranch_scc0 WL_12
    s_branch FAIL
SY_14:
    ds_read_b128 v[56:59], v19 offset:0
    ds_read_b128 v[26:29], v4 offset:0
    ds_read_b128 v[30:33], v4 offset:128
    ds_read_b128 v[34:37], v4 offset:256
    ds_read_b128 v[38:41], v4 offset:384
    s_sub_u32 s32, s32, 1
    s_cbranch_scc0 SC_15
    s_branch FAIL
HPR:
    buffer_load_dwordx2 v[24:25], v53, s[4:7], 0 offen sc1
    s_sub_u32 s32, s32, 1
    s_cbranch_scc0 HP1
    s_branch FAIL
RT_16:
    s_sub_u32 s32, s32, 1
    s_cbranch_scc0 WM
    s_branch FAIL
SLOWCLR:
    v_mov_b32 v36, -1
    v_mov_b32 v37, -1
    v_mov_b32 v38, -1
    v_mov_b32 v39, -1
    s_cmp_eq_u32 s3, 0
    s_cbranch_scc1 SLOW0
    buffer_store_dwordx4 v[36:39], v54, s[4:7], s90 offen sc1
    s_cmp_lg_u32 s3, 1
    s_cbranch_scc1 GC_17
    s_mov_b64 exec, 255
    buffer_store_dwordx4 v[36:39], v54, s[4:7], s91 offen sc1
    s_mov_b64 exec, -1
GC_17:
    s_waitcnt vmcnt(0)
    ds_write_b32 v20, v21
    s_branch SLOW2
SLOW0:
    ds_write_b32 v20, v21
HS_18:
    ds_read_b128 v[56:59], v19 offset:0
    s_waitcnt lgkmcnt(0)
    v_min3_u32 v56, v56, v57, v58
    v_min_u32 v56, v56, v59
    v_cmp_gt_u32 vcc, 3, v56
    s_cbranch_vccnz RT_19

    s_add_u32 s58, s62, 1
    v_mov_b32 v40, s58
    v_mov_b32 v41, s89
    s_mov_b64 exec, 1
    buffer_store_dwordx2 v[40:41], off, s[4:7], s85 sc1
    s_mov_b64 exec, -1
SLOW1:
    buffer_load_dword v41, v53, s[4:7], 0 offen sc1
    s_waitcnt vmcnt(0)
    v_cmp_ne_u32 vcc, s58, v41

    s_cbranch_vccnz RT_20
    v_mov_b32 v40, 1
    ds_write_b32 v19, v40 offset:32

SLOW2:
    ds_read_b32 v56, v19 offset:32
    s_waitcnt lgkmcnt(0)
    v_cmp_ne_u32 vcc, 1, v56
    s_cbranch_vccnz RT_21
    v_add_u32 v21, 1, v21
    s_mov_b32 s31, 1
    s_branch WM2

RT_19:
    s_sub_u32 s32, s32, 1
    s_cbranch_scc0 HS_18
    s_branch FAIL
RT_20:
    s_sub_u32 s32, s32, 1
    s_cbranch_scc0 SLOW1
    s_branch FAIL
RT_21:
    s_sub_u32 s32, s32, 1
    s_cbranch_scc0 SLOW2
    s_branch FAIL
SS_22:
    buffer_store_dword v44, v6, s[4:7], s19 offen sc1
    s_branch SB_23
SS_24:
    buffer_store_dwordx4 v[36:39], v54, s[4:7], s58 offen sc1
    s_branch SB_25
SS_27:
    buffer_store_dwordx4 v[36:39], v54, s[4:7], s59 offen sc1
    s_branch SB_28
RT_30:
    s_sub_u32 s32, s32, 1
    s_cbranch_scc0 RX0
    s_branch FAIL
RT_32:
    s_sub_u32 s32, s32, 1
    s_cbranch_scc0 CSG_31
    s_branch FAIL
SY_33:
    ds_read_b128 v[56:59], v19 offset:0
    s_sub_u32 s32, s32, 1
    s_cbranch_scc0 SC_34
    s_branch FAIL
SY_35:
    ds_read_b128 v[56:59], v19 offset:0
    ds_read_b128 v[26:29], v19 offset:64
    ds_read_b128 v[30:33], v19 offset:80
    s_sub_u32 s32, s32, 1
    s_cbranch_scc0 SC_36
    s_branch FAIL
RT_37:
    s_sub_u32 s32, s32, 1
    s_cbranch_scc0 BW
    s_branch FAIL
AR:
    buffer_load_dwordx4 v[52:55], v0, s[4:7], s16 offen sc1
    buffer_load_dwordx4 v[56:59], v0, s[4:7], s16 offen offset:2048 sc1
    buffer_load_dword v42, v1, s[4:7], s17 offen sc1

    s_sub_u32 s32, s32, 1
    v_mov_b32 v34, 0
    v_mov_b32 v35, 0
    s_cbranch_scc0 AW
    s_branch FAIL
AF1:
    s_sub_u32 s32, s32, 1
    s_cbranch_scc1 FAIL
    s_cmp_eq_u32 s2, 6
    s_cbranch_scc1 APOLL
AF:
    buffer_load_dwordx4 v[26:29], v0, s[4:7], s16 offen sc1
    buffer_load_dwordx4 v[30:33], v0, s[4:7], s16 offen offset:2048 sc1
    buffer_load_dword v42, v1, s[4:7], s17 offen sc1

    v_mov_b32 v44, s36
    v_mov_b32 v45, s37
    v_mov_b32 v46, 0x44444444
    v_mov_b32 v47, 0xeeeeeeee
    v_cndmask_b32 v44, v44, v45, s[54:55]
    v_mov_b32 v38, 0
    v_mov_b32 v39, 0
    v_mov_b32_dpp v46, v47 quad_perm:[0,1,2,3] row_mask:0xf bank_mask:0xa
    v_mov_b32_dpp v38, v44 quad_perm:[0,1,2,3] row_mask:0xf bank_mask:0x3
    v_mov_b32_dpp v39, v44 quad_perm:[0,1,2,3] row_mask:0xf bank_mask:0xc
    v_mov_b32 v34, 0
    v_mov_b32 v35, 0
    v_mov_b32 v40, v38
    v_mov_b32 v41, v39

    s_mov_b32 s101, 0
    s_call_b64 s[0:1], LD
    s_waitcnt vmcnt(2)
    v_max3_u32 v44, v26, v27, v28
    s_waitcnt vmcnt(1)
    v_max3_u32 v45, v30, v31, v32
    v_max3_u32 v44, v44, v29, v33
    v_smfmac_f32_16x16x64_bf16 v[34:37], v[38:41], v[26:33], v46
    s_waitcnt vmcnt(0)
    v_max3_u32 v44, v44, v45, v42
    v_and_b32 v45, 0xffff0000, v42
    v_cmp_eq_u32 vcc, -1, v44
    v_lshlrev_b32 v44, 16, v42
    s_cbranch_vccnz AF1

    s_branch AU
PAD_O1:
    s_branch PADRET
SS_40:
    buffer_store_dwordx2 v[46:47], off, s[4:7], s20 sc1
    s_branch SB_41
SY_38:
    ds_read_b128 v[60:63], v19 offset:0
    ds_read_b32 v50, v19 offset:36
    ds_read_b128 v[26:29], v4 offset:0
    ds_read_b128 v[30:33], v4 offset:128
    ds_read_b128 v[34:37], v4 offset:256
    ds_read_b128 v[38:41], v4 offset:384
    s_sub_u32 s32, s32, 1
    s_cbranch_scc0 SC_39
    s_branch FAIL
SS_42:
    buffer_store_dword v44, v6, s[4:7], s19 offen sc1
    s_branch SB_43
BF:
    buffer_load_dwordx4 v[56:59], v7, s[4:7], s21 offen sc1
    buffer_load_dwordx4 v[28:31], v8, s[4:7], s22 offen offset:0 sc1
    buffer_load_dwordx4 v[32:35], v8, s[4:7], s22 offen offset:512 sc1
    buffer_load_dwordx4 v[36:39], v8, s[4:7], s22 offen offset:1024 sc1
    buffer_load_dwordx4 v[40:43], v8, s[4:7], s22 offen offset:1536 sc1
    s_cmp_eq_u32 s2, 6
    s_cbranch_scc1 BF1
    s_mov_b32 s101, 1
    s_call_b64 s[0:1], LD
BF1:
    v_mov_b32 v44, 0
    v_mov_b32 v45, 0
    v_mov_b32 v46, 0
    v_mov_b32 v47, 0
    v_mov_b32 v48, 0
    v_mov_b32 v49, 0
    v_mov_b32 v50, 0
    v_mov_b32 v51, 0
    s_waitcnt vmcnt(4)
    v_pk_add_f32 v[26:27], v[56:57], v[58:59]
    v_cmp_u_f32 vcc, v26, v27
    s_cbranch_vccz BS
    s_sub_u32 s32, s32, 1
    s_cbranch_scc0 BF
    s_branch FAIL
RT_44:
    s_sub_u32 s32, s32, 1
    s_cbranch_scc0 BST
    s_branch FAIL
RB_45:
    buffer_load_dwordx4 v[28:31], v8, s[4:7], s22 offen offset:0 sc1
    buffer_load_dwordx4 v[32:35], v8, s[4:7], s22 offen offset:512 sc1
    buffer_load_dwordx4 v[36:39], v8, s[4:7], s22 offen offset:1024 sc1
    buffer_load_dwordx4 v[40:43], v8, s[4:7], s22 offen offset:1536 sc1
    s_sub_u32 s32, s32, 1
    s_cbranch_scc0 BQ2
    s_branch FAIL
SY_46:
    ds_read_b128 v[56:59], v19 offset:0
    ds_read_b128 v[26:29], v10 offset:0
    ds_read_b128 v[30:33], v10 offset:1152
    s_sub_u32 s32, s32, 1
    s_cbranch_scc0 SC_47
    s_branch FAIL
SY_48:
    ds_read_b128 v[56:59], v19 offset:0
    ds_read_b128 v[26:29], v12 offset:0
    ds_read_b128 v[30:33], v12 offset:16
    s_sub_u32 s32, s32, 1
    s_cbranch_scc0 SC_49
    s_branch FAIL
LC_52:
    s_cmp_ge_u32 s2, 2
    s_cbranch_scc1 LB_53
    s_mov_b32 s101, 2
    s_call_b64 s[0:1], LD
    s_branch LB_53
SY_50:
    ds_read_b128 v[56:59], v19 offset:0
    ds_read_b128 v[32:35], v10 offset:2304
    ds_read_b128 v[36:39], v10 offset:3456
    s_sub_u32 s32, s32, 1
    s_cbranch_scc0 SC_51
    s_branch FAIL
SS_55:
    buffer_store_dword v40, v14, s[4:7], s23 offen sc1
    s_branch SB_56
SS_57:
    buffer_store_dword v40, v15, s[4:7], s23 offen offset:1024 sc1
    s_branch SB_58
SS_59:
    buffer_store_dword v44, v16, s[4:7], s25 offen sc1
    buffer_store_dword v46, v16, s[4:7], s26 offen sc1
    s_branch SB_60
RT_61:
    s_sub_u32 s32, s32, 1
    s_cbranch_scc0 CM
    s_branch FAIL
CF:
    buffer_load_dwordx4 v[26:29], v17, s[4:7], s24 offen sc1
    s_cmp_eq_u32 s2, 6
    s_cbranch_scc1 CF1
    s_mov_b32 s101, 0
    s_call_b64 s[0:1], LD
CF1:
    s_waitcnt vmcnt(0)
    v_pk_add_f32 v[50:51], v[26:27], v[28:29]
    v_cmp_u_f32 vcc, v50, v51
    s_cbranch_vccz CL
    s_sub_u32 s32, s32, 1
    s_cbranch_scc0 CF
    s_branch FAIL
RC_62:
    s_waitcnt lgkmcnt(0)
    buffer_load_dwordx4 v[30:33], v17, s[4:7], s24 offen offset:1024 sc1
    buffer_load_dwordx4 v[34:37], v0, s[4:7], s27 offen offset:0 sc1
    buffer_load_dwordx4 v[38:41], v0, s[4:7], s27 offen offset:2048 sc1
    buffer_load_dwordx4 v[42:45], v0, s[4:7], s28 offen offset:0 sc1
    buffer_load_dwordx4 v[46:49], v0, s[4:7], s28 offen offset:2048 sc1
    s_sub_u32 s32, s32, 1
    s_cbranch_scc0 CO2
    s_branch FAIL
LC_65:
    s_mov_b32 s101, 6
    s_call_b64 s[0:1], LD
    s_branch LB_66
SY_63:
    ds_read_b128 v[56:59], v19 offset:0
    ds_read_b128 v[26:29], v4 offset:1024
    ds_read_b128 v[30:33], v4 offset:1152
    ds_read_b128 v[34:37], v4 offset:1280
    ds_read_b128 v[38:41], v4 offset:1408
    s_sub_u32 s32, s32, 1
    s_cbranch_scc0 SC_64
    s_branch FAIL

.section .rodata,"a"
.p2align 6
.amdhsa_kernel interleave_layers__sliding_block_cached__sliding_block_cached__decode_kernel
  .amdhsa_next_free_vgpr 256
  .amdhsa_next_free_sgpr 102
  .amdhsa_accum_offset 64
  .amdhsa_group_segment_fixed_size 0
  .amdhsa_kernarg_size 104
  .amdhsa_user_sgpr_count 2
  .amdhsa_user_sgpr_kernarg_segment_ptr 1
  .amdhsa_system_sgpr_workgroup_id_x 1
.end_amdhsa_kernel
```
